```python
import torch

def _softmax(x, axis=-1):
    return torch.softmax(x, dim=axis)
def _gelu(x):
    return torch.nn.functional.gelu(x, approximate="tanh")
def _silu(x):
    return torch.nn.functional.silu(x)
def _sigmoid(x):
    return torch.sigmoid(x)
def _layernorm(x, axis=-1, eps=1e-5):
    m = x.mean(dim=axis, keepdim=True)
    v = x.var(dim=axis, keepdim=True, unbiased=False)
    return (x - m) / torch.sqrt(v + eps)
def _scatter_add(tgt, idx, src, axis=0):
    return tgt.clone().index_add_(axis, idx, src)
def _segment_sum(src, seg, n):
    out = torch.zeros((n,) + src.shape[1:], dtype=src.dtype)
    return out.index_add_(0, seg, src)
def _pad(x, pw):
    flat = tuple(v for pair in reversed(pw) for v in pair)
    return torch.nn.functional.pad(x, flat)

kernel_name = 'recurrent_scan__sliding_block_cached__glu_gated_bilinear__decode'

def setup_inputs():

    _w = (lambda a: (lambda t: t.to(torch.bfloat16) if t.is_floating_point() else t)(torch.as_tensor(a)))
    def _A_setup():
        B, Sq, D = 8, 1, 576
        Hq, Hkv, Sk, Dh = 32, 16, 4096, 128
        assert Hq % Hkv == 0, (Hq, Hkv)
        return {
            "x": _w((lambda *s: torch.randn(*s, dtype=torch.bfloat16) * 0.05)(B, Sq, D)),
            "k_cache": _w((lambda *s: torch.randn(*s, dtype=torch.bfloat16) * 3.2)(B, Hkv, Sk, Dh)),
            "v_cache": _w((lambda *s: torch.randn(*s, dtype=torch.bfloat16) * 3.2)(B, Hkv, Sk, Dh)),
            "wq": _w((lambda *s: torch.randn(*s, dtype=torch.bfloat16) * 3.2)(D, Hq * Dh) * (D ** -0.5)),
            "wo": _w((lambda *s: torch.randn(*s, dtype=torch.bfloat16) * 3.2)(Hq * Dh, D) * ((Hq * Dh) ** -0.5)),
        }
    _A_in = _A_setup()

    def _B_setup():
        B, S, D, F = 8, 1, 576, 4608
        return {
            "x": _w((lambda *s: torch.randn(*s, dtype=torch.bfloat16) * 0.05)(B, S, D)),
            "w_gate": _w((lambda *s: torch.randn(*s, dtype=torch.bfloat16) * 0.4)(D, F) * (D ** -0.5)),
            "w_up": _w((lambda *s: torch.randn(*s, dtype=torch.bfloat16) * 0.4)(D, F) * (D ** -0.5)),
            "w_down": _w((lambda *s: torch.randn(*s, dtype=torch.bfloat16) * 0.4)(F, D) * (F ** -0.5)),
        }
    _B_in = _B_setup()

    return {
        "A_x": _A_in["x"],
        "A_k_cache": _A_in["k_cache"],
        "A_v_cache": _A_in["v_cache"],
        "A_wq": _A_in["wq"],
        "A_wo": _A_in["wo"],
        "B_x": _B_in["x"],
        "B_w_gate": _B_in["w_gate"],
        "B_w_up": _B_in["w_up"],
        "B_w_down": _B_in["w_down"],
    }

def reference(A_x, A_k_cache, A_v_cache, A_wq, A_wo, B_x, B_w_gate, B_w_up, B_w_down):
    def _A_ref(x, k_cache, v_cache, wq, wo):
        B, Sq, D = x.shape
        Hq, Dh = 32, 128
        Hkv, Sk = k_cache.shape[1], k_cache.shape[2]
        W = min(4096, max(256, Sk // 4))
        rep = Hq // Hkv
        q = (lambda x, *d: x.permute(*d))((x @ wq).reshape(B, Sq, Hq, Dh), 0, 2, 1, 3)
        k = (lambda x, n, axis: torch.repeat_interleave(x, n, dim=axis))(k_cache[:, :, Sk - W:, :], rep, axis=1)
        v = (lambda x, n, axis: torch.repeat_interleave(x, n, dim=axis))(v_cache[:, :, Sk - W:, :], rep, axis=1)
        scores = torch.einsum("bhqd,bhkd->bhqk", q, k) * (Dh ** -0.5)
        p = _softmax(scores, axis=-1)
        o = torch.einsum("bhqk,bhkd->bhqd", p, v)
        return (lambda x, *d: x.permute(*d))(o, 0, 2, 1, 3).reshape(B, Sq, Hq * Dh) @ wo

    def _B_ref(x, w_gate, w_up, w_down):
        g = torch.einsum("bsd,df->bsf", x, w_gate)
        u = torch.einsum("bsd,df->bsf", x, w_up)
        h = g * u
        return torch.einsum("bsf,fd->bsd", h, w_down)

    x = A_x
    xn = _layernorm(x, axis=-1)
    s = _A_ref(xn, A_k_cache, A_v_cache, A_wq, A_wo)
    g = _silu(_B_ref(xn, B_w_gate, B_w_up, B_w_down))
    return x + s * g
```

```asm
; @launch grid=(256,1,1) block=(1024,1,1) lds=163840
.amdgcn_target "amdgcn-amd-amdhsa--gfx950"
.text
.globl recurrent_scan__sliding_block_cached__glu_gated_bilinear__decode_kernel
.p2align 8
.type recurrent_scan__sliding_block_cached__glu_gated_bilinear__decode_kernel,@function
recurrent_scan__sliding_block_cached__glu_gated_bilinear__decode_kernel:
  s_cmp_ge_u32 s2, 256
  s_cbranch_scc1 L_end
  s_load_dwordx16 s[4:19], s[0:1], 0
  s_load_dwordx8 s[20:27], s[0:1], 64
  v_lshrrev_b32 v1, 6, v0
  v_and_b32 v0, 63, v0
  s_and_b32 s28, s2, 7
  v_readfirstlane_b32 s3, v1
  s_lshr_b32 s29, s2, 3
  s_mov_b32 s62, 0
  s_cmp_ge_u32 s29, 16
  s_cbranch_scc1 L_notA
  s_lshr_b32 s30, s29, 3
  s_lshl_b32 s31, s28, 1
  s_add_u32 s52, s31, s30
  s_and_b32 s53, s29, 7
  s_lshl_b32 s30, s53, 4
  s_add_u32 s30, s30, s52
  s_lshl_b32 s30, s30, 20
  s_lshl_b32 s31, s3, 14
  s_add_u32 s30, s30, s31
  s_add_u32 s57, s30, 786432
  s_xor_b32 s63, s29, s3
  s_and_b32 s63, s63, 1
  s_lshl_b32 s63, s63, 13
  s_xor_b32 s54, s63, 0x1000
  s_xor_b32 s55, s63, 0x2000
  s_xor_b32 s56, s63, 0x3000
  v_bfe_u32 v1, v0, 2, 2
  v_lshlrev_b32 v1, 8, v1
  v_lshrrev_b32 v3, 4, v0
  v_lshl_add_u32 v1, v3, 6, v1
  v_and_b32 v4, 3, v0
  v_lshl_add_u32 v1, v4, 4, v1
  v_lshlrev_b32 v2, 4, v0
  v_mov_b32 v8, 0
  v_mov_b32 v9, 0
  s_setprio 3
  ds_write_b64 v8, v[8:9] offset:1024
  s_waitcnt lgkmcnt(0)
  s_add_u32 s32, s6, s57
  s_addc_u32 s33, s7, 0
  s_mov_b32 s34, 16384
  s_mov_b32 s35, 0x20000
  buffer_load_dwordx4 v[64:67], v1, s[32:35], s63 offen offset:0 nt
  buffer_load_dwordx4 v[68:71], v1, s[32:35], s63 offen offset:1024 nt
  buffer_load_dwordx4 v[72:75], v1, s[32:35], s63 offen offset:2048 nt
  s_barrier
  buffer_load_dwordx4 v[76:79], v1, s[32:35], s63 offen offset:3072 nt
  buffer_load_dwordx4 v[80:83], v1, s[32:35], s54 offen offset:0 nt
  buffer_load_dwordx4 v[84:87], v1, s[32:35], s54 offen offset:1024 nt
  buffer_load_dwordx4 v[88:91], v1, s[32:35], s54 offen offset:2048 nt
  buffer_load_dwordx4 v[92:95], v1, s[32:35], s54 offen offset:3072 nt
  buffer_load_dwordx4 v[96:99], v1, s[32:35], s55 offen offset:0 nt
  buffer_load_dwordx4 v[100:103], v1, s[32:35], s55 offen offset:1024 nt
  buffer_load_dwordx4 v[104:107], v1, s[32:35], s55 offen offset:2048 nt
  buffer_load_dwordx4 v[108:111], v1, s[32:35], s55 offen offset:3072 nt
  buffer_load_dwordx4 v[112:115], v1, s[32:35], s56 offen offset:0 nt
  buffer_load_dwordx4 v[116:119], v1, s[32:35], s56 offen offset:1024 nt
  buffer_load_dwordx4 v[120:123], v1, s[32:35], s56 offen offset:2048 nt
  buffer_load_dwordx4 v[124:127], v1, s[32:35], s56 offen offset:3072 nt
  s_add_u32 s36, s8, s57
  s_addc_u32 s37, s9, 0
  s_mov_b32 s38, 16384
  s_mov_b32 s39, 0x20000
  s_mov_b32 s48, s26
  s_mov_b32 s49, s27
  s_mov_b32 s50, 268435456
  s_mov_b32 s51, 0x20000
  s_lshl_b32 s30, s52, 12
  s_lshl_b32 s31, s53, 7
  s_add_u32 s58, s30, s31
  s_bfe_u32 s68, s58, 0x4000c
  s_lshl_b32 s68, s68, 23
  s_or_b32 s58, s58, s68
  s_setprio 0
  v_bfe_u32 v5, v0, 3, 1
  v_lshlrev_b32 v5, 8, v5
  v_lshl_add_u32 v5, v3, 6, v5
  v_lshl_add_u32 v10, v4, 4, v5
  s_cmp_ge_u32 s3, 4
  s_cbranch_scc1 L_A_wait0
  s_lshl_b32 s30, s3, 10
  s_add_u32 s30, s30, s58
  s_add_u32 s60, s26, s30
  s_addc_u32 s61, s27, 0
  s_lshl_b32 s30, s3, 7
  v_lshl_add_u32 v11, v0, 2, s30
  s_waitcnt vmcnt(0)
  s_sleep 36
  s_load_dword s30, s[24:25], 0
  s_waitcnt lgkmcnt(0)
  s_cmp_ge_u32 s30, 13
  s_cbranch_scc1 L_ccd_a
  s_sleep 20
  s_load_dword s30, s[24:25], 64
  s_waitcnt lgkmcnt(0)
  s_cmp_ge_u32 s30, 13
  s_cbranch_scc1 L_ccd_a
  s_sleep 20
  s_load_dword s30, s[24:25], 128
  s_waitcnt lgkmcnt(0)
  s_cmp_ge_u32 s30, 13
  s_cbranch_scc1 L_ccd_a
  s_sleep 20
  v_mov_b32 v12, 0
L_cc_a:
  global_load_dword v13, v12, s[24:25] sc1
  s_waitcnt vmcnt(0)
  v_readfirstlane_b32 s30, v13
  s_cmp_ge_u32 s30, 13
  s_cbranch_scc1 L_ccd_a
  s_sleep 16
  s_add_u32 s62, s62, 1
  s_cmp_lt_u32 s62, 0x40000
  s_cbranch_scc1 L_cc_a
L_ccd_a:
L_A_qpoll:
  s_load_dwordx16 s[4:19], s[60:61], 0 glc
  s_load_dwordx16 s[84:99], s[60:61], 64 glc
  s_waitcnt lgkmcnt(0)
  s_max_u32 s30, s4, s12
  s_max_u32 s31, s84, s92
  s_max_u32 s30, s30, s31
  s_cmp_eq_u32 s30, -1
  s_cbranch_scc1 L_A_qagain
  v_writelane_b32 v9, s4, 0
  v_writelane_b32 v9, s5, 1
  v_writelane_b32 v9, s6, 2
  v_writelane_b32 v9, s7, 3
  v_writelane_b32 v9, s8, 4
  v_writelane_b32 v9, s9, 5
  v_writelane_b32 v9, s10, 6
  v_writelane_b32 v9, s11, 7
  v_writelane_b32 v9, s12, 8
  v_writelane_b32 v9, s13, 9
  v_writelane_b32 v9, s14, 10
  v_writelane_b32 v9, s15, 11
  v_writelane_b32 v9, s16, 12
  v_writelane_b32 v9, s17, 13
  v_writelane_b32 v9, s18, 14
  v_writelane_b32 v9, s19, 15
  v_writelane_b32 v9, s84, 16
  v_writelane_b32 v9, s85, 17
  v_writelane_b32 v9, s86, 18
  v_writelane_b32 v9, s87, 19
  v_writelane_b32 v9, s88, 20
  v_writelane_b32 v9, s89, 21
  v_writelane_b32 v9, s90, 22
  v_writelane_b32 v9, s91, 23
  v_writelane_b32 v9, s92, 24
  v_writelane_b32 v9, s93, 25
  v_writelane_b32 v9, s94, 26
  v_writelane_b32 v9, s95, 27
  v_writelane_b32 v9, s96, 28
  v_writelane_b32 v9, s97, 29
  v_writelane_b32 v9, s98, 30
  v_writelane_b32 v9, s99, 31
  s_mov_b32 exec_hi, 0
  v_cmp_eq_u32 vcc, -1, v9
  s_cbranch_vccz L_A_qgot
  s_mov_b32 exec_hi, -1
L_A_qagain:
  s_sleep 16
  s_add_u32 s62, s62, 1
  s_cmp_lt_u32 s62, 0x40000
  s_cbranch_scc1 L_A_qpoll
  s_mov_b32 exec_hi, 0
L_A_qgot:
  ds_write_b32 v11, v9 offset:0
  v_mov_b32 v9, 1
  s_mov_b64 exec, 1
  ds_add_u32 v8, v9 offset:1024
  s_mov_b64 exec, -1
  s_branch L_A_qspin
L_A_wait0:
  s_setprio 2
  buffer_load_dwordx4 v[36:39], v2, s[36:39], s63 offen offset:0 nt
  buffer_load_dwordx4 v[40:43], v2, s[36:39], s63 offen offset:1024 nt
  buffer_load_dwordx4 v[44:47], v2, s[36:39], s63 offen offset:2048 nt
  s_waitcnt vmcnt(3)
L_A_qspin:
  ds_read_b32 v9, v8 offset:1024
  ds_read_b128 v[4:7], v10 offset:0
  s_waitcnt lgkmcnt(0)
  v_readfirstlane_b32 s30, v9
  s_cmp_ge_u32 s30, 4
  s_cbranch_scc1 L_A_qk
  s_sleep 3
  s_add_u32 s62, s62, 1
  s_cmp_lt_u32 s62, 0x40000
  s_cbranch_scc1 L_A_qspin
L_A_qk:
  s_setprio 0
  v_and_b32 v9, 4, v0
  v_cmp_eq_u32 vcc, 0, v9
  s_nop 1
  v_cndmask_b32 v32, v4, 0, vcc
  v_cndmask_b32 v33, v5, 0, vcc
  v_cndmask_b32 v34, v6, 0, vcc
  v_cndmask_b32 v35, v7, 0, vcc
  v_cndmask_b32 v4, 0, v4, vcc
  v_cndmask_b32 v5, 0, v5, vcc
  v_cndmask_b32 v6, 0, v6, vcc
  v_cndmask_b32 v7, 0, v7, vcc
  s_mov_b32 s30, 0x3db504f3
  s_mov_b32 s31, 0x3fb8aa3b
  v_mfma_f32_16x16x32_bf16 v[16:19], v[64:67], v[4:7], 0
  v_mfma_f32_16x16x32_bf16 v[20:23], v[72:75], v[4:7], 0
  v_mfma_f32_16x16x32_bf16 v[24:27], v[80:83], v[4:7], 0
  v_mfma_f32_16x16x32_bf16 v[28:31], v[88:91], v[4:7], 0
  v_mfma_f32_16x16x32_bf16 v[16:19], v[68:71], v[32:35], v[16:19]
  v_mfma_f32_16x16x32_bf16 v[20:23], v[76:79], v[32:35], v[20:23]
  v_mfma_f32_16x16x32_bf16 v[24:27], v[84:87], v[32:35], v[24:27]
  v_mfma_f32_16x16x32_bf16 v[28:31], v[92:95], v[32:35], v[28:31]
  v_mfma_f32_16x16x32_bf16 v[64:67], v[96:99], v[4:7], 0
  v_mfma_f32_16x16x32_bf16 v[68:71], v[104:107], v[4:7], 0
  v_mfma_f32_16x16x32_bf16 v[72:75], v[112:115], v[4:7], 0
  v_mfma_f32_16x16x32_bf16 v[76:79], v[120:123], v[4:7], 0
  v_mfma_f32_16x16x32_bf16 v[64:67], v[100:103], v[32:35], v[64:67]
  v_mfma_f32_16x16x32_bf16 v[68:71], v[108:111], v[32:35], v[68:71]
  v_mfma_f32_16x16x32_bf16 v[72:75], v[116:119], v[32:35], v[72:75]
  v_mfma_f32_16x16x32_bf16 v[76:79], v[124:127], v[32:35], v[76:79]
  v_mov_b32_dpp v48, v16 quad_perm:[0,0,0,0] row_mask:0xf bank_mask:0xf
  v_mov_b32_dpp v49, v20 quad_perm:[0,0,0,0] row_mask:0xf bank_mask:0xf
  v_mov_b32_dpp v50, v24 quad_perm:[0,0,0,0] row_mask:0xf bank_mask:0xf
  v_mov_b32_dpp v51, v28 quad_perm:[0,0,0,0] row_mask:0xf bank_mask:0xf
  v_add_f32_dpp v48, v17, v48 quad_perm:[1,1,1,1] row_mask:0xf bank_mask:0xf
  v_add_f32_dpp v49, v21, v49 quad_perm:[1,1,1,1] row_mask:0xf bank_mask:0xf
  v_add_f32_dpp v50, v25, v50 quad_perm:[1,1,1,1] row_mask:0xf bank_mask:0xf
  v_add_f32_dpp v51, v29, v51 quad_perm:[1,1,1,1] row_mask:0xf bank_mask:0xf
  v_add_f32_dpp v48, v18, v48 quad_perm:[2,2,2,2] row_mask:0xf bank_mask:0xf
  v_add_f32_dpp v49, v22, v49 quad_perm:[2,2,2,2] row_mask:0xf bank_mask:0xf
  v_add_f32_dpp v50, v26, v50 quad_perm:[2,2,2,2] row_mask:0xf bank_mask:0xf
  v_add_f32_dpp v51, v30, v51 quad_perm:[2,2,2,2] row_mask:0xf bank_mask:0xf
  v_add_f32_dpp v48, v19, v48 quad_perm:[3,3,3,3] row_mask:0xf bank_mask:0xf
  v_add_f32_dpp v49, v23, v49 quad_perm:[3,3,3,3] row_mask:0xf bank_mask:0xf
  v_add_f32_dpp v50, v27, v50 quad_perm:[3,3,3,3] row_mask:0xf bank_mask:0xf
  v_add_f32_dpp v51, v31, v51 quad_perm:[3,3,3,3] row_mask:0xf bank_mask:0xf
  v_mov_b32_dpp v52, v64 quad_perm:[0,0,0,0] row_mask:0xf bank_mask:0xf
  v_mov_b32_dpp v53, v68 quad_perm:[0,0,0,0] row_mask:0xf bank_mask:0xf
  v_mov_b32_dpp v54, v72 quad_perm:[0,0,0,0] row_mask:0xf bank_mask:0xf
  v_mov_b32_dpp v55, v76 quad_perm:[0,0,0,0] row_mask:0xf bank_mask:0xf
  v_add_f32_dpp v52, v65, v52 quad_perm:[1,1,1,1] row_mask:0xf bank_mask:0xf
  v_add_f32_dpp v53, v69, v53 quad_perm:[1,1,1,1] row_mask:0xf bank_mask:0xf
  v_add_f32_dpp v54, v73, v54 quad_perm:[1,1,1,1] row_mask:0xf bank_mask:0xf
  v_add_f32_dpp v55, v77, v55 quad_perm:[1,1,1,1] row_mask:0xf bank_mask:0xf
  v_add_f32_dpp v52, v66, v52 quad_perm:[2,2,2,2] row_mask:0xf bank_mask:0xf
  v_add_f32_dpp v53, v70, v53 quad_perm:[2,2,2,2] row_mask:0xf bank_mask:0xf
  v_add_f32_dpp v54, v74, v54 quad_perm:[2,2,2,2] row_mask:0xf bank_mask:0xf
  v_add_f32_dpp v55, v78, v55 quad_perm:[2,2,2,2] row_mask:0xf bank_mask:0xf
  v_add_f32_dpp v52, v67, v52 quad_perm:[3,3,3,3] row_mask:0xf bank_mask:0xf
  v_add_f32_dpp v53, v71, v53 quad_perm:[3,3,3,3] row_mask:0xf bank_mask:0xf
  v_add_f32_dpp v54, v75, v54 quad_perm:[3,3,3,3] row_mask:0xf bank_mask:0xf
  v_add_f32_dpp v55, v79, v55 quad_perm:[3,3,3,3] row_mask:0xf bank_mask:0xf
  v_cvt_pk_bf16_f32 v12, v48, v49
  v_lshlrev_b32 v48, 16, v12
  v_and_b32 v49, 0xffff0000, v12
  v_mul_f32 v48, s30, v48
  v_mul_f32 v49, s30, v49
  v_cvt_pk_bf16_f32 v13, v48, v49
  v_lshlrev_b32 v48, 16, v13
  v_and_b32 v49, 0xffff0000, v13
  v_cvt_pk_bf16_f32 v12, v50, v51
  v_lshlrev_b32 v50, 16, v12
  v_and_b32 v51, 0xffff0000, v12
  v_mul_f32 v50, s30, v50
  v_mul_f32 v51, s30, v51
  v_cvt_pk_bf16_f32 v13, v50, v51
  v_lshlrev_b32 v50, 16, v13
  v_and_b32 v51, 0xffff0000, v13
  v_cvt_pk_bf16_f32 v12, v52, v53
  v_lshlrev_b32 v52, 16, v12
  v_and_b32 v53, 0xffff0000, v12
  v_mul_f32 v52, s30, v52
  v_mul_f32 v53, s30, v53
  v_cvt_pk_bf16_f32 v13, v52, v53
  v_lshlrev_b32 v52, 16, v13
  v_and_b32 v53, 0xffff0000, v13
  v_cvt_pk_bf16_f32 v12, v54, v55
  v_lshlrev_b32 v54, 16, v12
  v_and_b32 v55, 0xffff0000, v12
  v_mul_f32 v54, s30, v54
  v_mul_f32 v55, s30, v55
  v_cvt_pk_bf16_f32 v13, v54, v55
  v_lshlrev_b32 v54, 16, v13
  v_and_b32 v55, 0xffff0000, v13
  v_max3_f32 v12, v48, v49, v50
  v_max3_f32 v12, v12, v51, v52
  v_max3_f32 v12, v12, v53, v54
  v_max_f32 v12, v12, v55
  s_nop 1
  v_max_f32_dpp v12, v12, v12 row_half_mirror row_mask:0xf bank_mask:0xf
  v_mov_b32 v14, v12
  s_nop 1
  v_permlane16_swap_b32 v12, v14
  v_max_f32 v12, v12, v14
  v_mov_b32 v14, v12
  s_nop 1
  v_permlane32_swap_b32 v12, v14
  v_max_f32 v12, v12, v14
  v_sub_f32 v48, v48, v12
  v_sub_f32 v49, v49, v12
  v_sub_f32 v50, v50, v12
  v_sub_f32 v51, v51, v12
  v_sub_f32 v52, v52, v12
  v_sub_f32 v53, v53, v12
  v_sub_f32 v54, v54, v12
  v_sub_f32 v55, v55, v12
  v_mul_f32 v48, s31, v48
  v_mul_f32 v49, s31, v49
  v_mul_f32 v50, s31, v50
  v_mul_f32 v51, s31, v51
  v_mul_f32 v52, s31, v52
  v_mul_f32 v53, s31, v53
  v_mul_f32 v54, s31, v54
  v_mul_f32 v55, s31, v55
  v_exp_f32 v48, v48
  v_exp_f32 v49, v49
  v_exp_f32 v50, v50
  v_exp_f32 v51, v51
  v_exp_f32 v52, v52
  v_exp_f32 v53, v53
  v_exp_f32 v54, v54
  v_exp_f32 v55, v55
  v_add_f32 v13, v48, v49
  v_add_f32 v13, v13, v50
  v_add_f32 v13, v13, v51
  v_add_f32 v13, v13, v52
  v_add_f32 v13, v13, v53
  v_add_f32 v13, v13, v54
  v_add_f32 v13, v13, v55
  s_nop 1
  v_add_f32_dpp v13, v13, v13 row_half_mirror row_mask:0xf bank_mask:0xf
  v_mov_b32 v14, v13
  s_nop 1
  v_permlane16_swap_b32 v13, v14
  v_add_f32 v13, v13, v14
  v_mov_b32 v14, v13
  s_nop 1
  v_permlane32_swap_b32 v13, v14
  v_add_f32 v13, v13, v14
  v_bfe_u32 v14, v0, 3, 1
  v_lshlrev_b32 v14, 7, v14
  s_lshl_b32 s30, s3, 3
  v_add_u32 v15, s30, v14
  v_mov_b32 v9, 1
  s_mov_b64 exec, 0x101
  ds_write_b64 v15, v[12:13] offset:1088
  s_mov_b64 exec, 1
  ds_add_u32 v8, v9 offset:1028
  s_mov_b64 exec, -1
  s_setprio 1
  s_cmp_ge_u32 s3, 4
  s_cbranch_scc1 L_A_v2
  buffer_load_dwordx4 v[36:39], v2, s[36:39], s63 offen offset:0 nt
  buffer_load_dwordx4 v[40:43], v2, s[36:39], s63 offen offset:1024 nt
  buffer_load_dwordx4 v[44:47], v2, s[36:39], s63 offen offset:2048 nt
L_A_v2:
  buffer_load_dwordx4 v[76:79], v2, s[36:39], s63 offen offset:3072 nt
  buffer_load_dwordx4 v[80:83], v2, s[36:39], s54 offen offset:0 nt
  buffer_load_dwordx4 v[84:87], v2, s[36:39], s54 offen offset:1024 nt
  buffer_load_dwordx4 v[88:91], v2, s[36:39], s54 offen offset:2048 nt
  buffer_load_dwordx4 v[92:95], v2, s[36:39], s54 offen offset:3072 nt
  buffer_load_dwordx4 v[96:99], v2, s[36:39], s55 offen offset:0 nt
  buffer_load_dwordx4 v[100:103], v2, s[36:39], s55 offen offset:1024 nt
  buffer_load_dwordx4 v[104:107], v2, s[36:39], s55 offen offset:2048 nt
  buffer_load_dwordx4 v[108:111], v2, s[36:39], s55 offen offset:3072 nt
  buffer_load_dwordx4 v[112:115], v2, s[36:39], s56 offen offset:0 nt
  buffer_load_dwordx4 v[116:119], v2, s[36:39], s56 offen offset:1024 nt
  buffer_load_dwordx4 v[120:123], v2, s[36:39], s56 offen offset:2048 nt
  buffer_load_dwordx4 v[124:127], v2, s[36:39], s56 offen offset:3072 nt
  s_setprio 0
  v_and_b32 v10, 7, v0
  v_and_b32 v11, 1, v3
  v_lshl_add_u32 v11, v11, 3, v10
  v_lshl_add_u32 v15, v11, 3, v14
  v_and_b32 v11, 1, v0
  v_lshlrev_b32 v11, 4, v11
  v_mov_b32 v20, 0xffff
  v_lshlrev_b32 v20, v11, v20
  v_lshrrev_b32 v10, 1, v10
  v_cmp_eq_u32 vcc, 0, v10
  s_nop 1
  v_cndmask_b32 v16, 0, v20, vcc
  v_cmp_eq_u32 vcc, 1, v10
  s_nop 1
  v_cndmask_b32 v17, 0, v20, vcc
  v_cmp_eq_u32 vcc, 2, v10
  s_nop 1
  v_cndmask_b32 v18, 0, v20, vcc
  v_cmp_eq_u32 vcc, 3, v10
  s_nop 1
  v_cndmask_b32 v19, 0, v20, vcc
L_A_mlspin:
  ds_read_b32 v9, v8 offset:1028
  ds_read_b64 v[22:23], v15 offset:1088
  s_waitcnt lgkmcnt(0)
  v_readfirstlane_b32 s30, v9
  s_cmp_ge_u32 s30, 16
  s_cbranch_scc1 L_A_mlgot
  s_sleep 3
  s_add_u32 s62, s62, 1
  s_cmp_lt_u32 s62, 0x40000
  s_cbranch_scc1 L_A_mlspin
L_A_mlgot:
  v_mov_b32 v24, v22
  s_nop 1
  v_max_f32_dpp v24, v24, v24 quad_perm:[1,0,3,2] row_mask:0xf bank_mask:0xf
  s_nop 1
  v_max_f32_dpp v24, v24, v24 quad_perm:[2,3,0,1] row_mask:0xf bank_mask:0xf
  s_nop 1
  v_max_f32_dpp v24, v24, v24 row_half_mirror row_mask:0xf bank_mask:0xf
  v_mov_b32 v25, v24
  s_nop 1
  v_permlane16_swap_b32 v24, v25
  v_max_f32 v24, v24, v25
  v_sub_f32 v22, v22, v24
  v_sub_f32 v12, v12, v24
  v_mul_f32 v22, s31, v22
  v_mul_f32 v12, s31, v12
  v_exp_f32 v22, v22
  v_exp_f32 v12, v12
  s_nop 0
  v_mul_f32 v23, v23, v22
  s_nop 1
  v_add_f32_dpp v23, v23, v23 quad_perm:[1,0,3,2] row_mask:0xf bank_mask:0xf
  s_nop 1
  v_add_f32_dpp v23, v23, v23 quad_perm:[2,3,0,1] row_mask:0xf bank_mask:0xf
  s_nop 1
  v_add_f32_dpp v23, v23, v23 row_half_mirror row_mask:0xf bank_mask:0xf
  v_mov_b32 v25, v23
  s_nop 1
  v_permlane16_swap_b32 v23, v25
  v_add_f32 v23, v23, v25
  v_rcp_f32 v23, v23
  s_nop 0
  v_mul_f32 v12, v12, v23
  v_mul_f32 v48, v12, v48
  v_mul_f32 v49, v12, v49
  v_mul_f32 v50, v12, v50
  v_mul_f32 v51, v12, v51
  v_mul_f32 v52, v12, v52
  v_mul_f32 v53, v12, v53
  v_mul_f32 v54, v12, v54
  v_mul_f32 v55, v12, v55
  v_cvt_pk_bf16_f32 v48, v48, v48
  v_cvt_pk_bf16_f32 v49, v49, v49
  v_cvt_pk_bf16_f32 v50, v50, v50
  v_cvt_pk_bf16_f32 v51, v51, v51
  v_cvt_pk_bf16_f32 v52, v52, v52
  v_cvt_pk_bf16_f32 v53, v53, v53
  v_cvt_pk_bf16_f32 v54, v54, v54
  v_cvt_pk_bf16_f32 v55, v55, v55
  v_mov_b32_dpp v4, v48 row_half_mirror row_mask:0xf bank_mask:0xf
  v_mov_b32_dpp v5, v49 row_half_mirror row_mask:0xf bank_mask:0xf
  v_mov_b32_dpp v6, v50 row_half_mirror row_mask:0xf bank_mask:0xf
  v_mov_b32_dpp v7, v51 row_half_mirror row_mask:0xf bank_mask:0xf
  v_mov_b32_dpp v32, v52 row_half_mirror row_mask:0xf bank_mask:0xf
  v_mov_b32_dpp v33, v53 row_half_mirror row_mask:0xf bank_mask:0xf
  v_mov_b32_dpp v34, v54 row_half_mirror row_mask:0xf bank_mask:0xf
  v_mov_b32_dpp v35, v55 row_half_mirror row_mask:0xf bank_mask:0xf
  s_lshl_b32 s30, s3, 10
  v_add_u32 v15, s30, v2
  v_bfe_u32 v11, v0, 1, 3
  v_and_b32 v13, 1, v0
  v_lshl_add_u32 v11, v13, 4, v11
  v_lshlrev_b32 v11, 4, v11
  v_lshl_add_u32 v11, v3, 12, v11
  s_and_b32 s31, s3, 1
  s_lshl_b32 s31, s31, 7
  s_lshr_b32 s60, s3, 1
  s_lshl_b32 s60, s60, 9
  s_add_u32 s31, s31, s60
  v_add_u32 v11, s31, v11
  v_and_b32 v10, 15, v0
  v_lshlrev_b32 v10, 3, v10
  v_lshrrev_b32 v13, 5, v0
  v_lshl_add_u32 v10, v13, 2, v10
  v_and_b32 v20, v48, v16
  v_and_b32 v21, v48, v17
  v_and_b32 v22, v4, v18
  v_and_b32 v23, v4, v19
  s_waitcnt vmcnt(15)
  s_nop 0
  v_mfma_f32_16x16x32_bf16 v[28:31], v[20:23], v[36:39], 0
  v_and_b32 v24, v4, v16
  v_and_b32 v25, v4, v17
  v_and_b32 v26, v48, v18
  v_and_b32 v27, v48, v19
  s_waitcnt vmcnt(14)
  s_nop 0
  v_mfma_f32_16x16x32_bf16 v[28:31], v[24:27], v[40:43], v[28:31]
  v_and_b32 v20, v49, v16
  v_and_b32 v21, v49, v17
  v_and_b32 v22, v5, v18
  v_and_b32 v23, v5, v19
  s_waitcnt vmcnt(13)
  s_nop 0
  v_mfma_f32_16x16x32_bf16 v[28:31], v[20:23], v[44:47], v[28:31]
  v_and_b32 v24, v5, v16
  v_and_b32 v25, v5, v17
  v_and_b32 v26, v49, v18
  v_and_b32 v27, v49, v19
  s_waitcnt vmcnt(12)
  s_nop 0
  v_mfma_f32_16x16x32_bf16 v[28:31], v[24:27], v[76:79], v[28:31]
  v_and_b32 v20, v50, v16
  v_and_b32 v21, v50, v17
  v_and_b32 v22, v6, v18
  v_and_b32 v23, v6, v19
  s_waitcnt vmcnt(11)
  s_nop 0
  v_mfma_f32_16x16x32_bf16 v[28:31], v[20:23], v[80:83], v[28:31]
  v_and_b32 v24, v6, v16
  v_and_b32 v25, v6, v17
  v_and_b32 v26, v50, v18
  v_and_b32 v27, v50, v19
  s_waitcnt vmcnt(10)
  s_nop 0
  v_mfma_f32_16x16x32_bf16 v[28:31], v[24:27], v[84:87], v[28:31]
  v_and_b32 v20, v51, v16
  v_and_b32 v21, v51, v17
  v_and_b32 v22, v7, v18
  v_and_b32 v23, v7, v19
  s_waitcnt vmcnt(9)
  s_nop 0
  v_mfma_f32_16x16x32_bf16 v[28:31], v[20:23], v[88:91], v[28:31]
  v_and_b32 v24, v7, v16
  v_and_b32 v25, v7, v17
  v_and_b32 v26, v51, v18
  v_and_b32 v27, v51, v19
  s_waitcnt vmcnt(8)
  s_nop 0
  v_mfma_f32_16x16x32_bf16 v[28:31], v[24:27], v[92:95], v[28:31]
  v_and_b32 v20, v52, v16
  v_and_b32 v21, v52, v17
  v_and_b32 v22, v32, v18
  v_and_b32 v23, v32, v19
  s_waitcnt vmcnt(7)
  s_nop 0
  v_mfma_f32_16x16x32_bf16 v[28:31], v[20:23], v[96:99], v[28:31]
  v_and_b32 v24, v32, v16
  v_and_b32 v25, v32, v17
  v_and_b32 v26, v52, v18
  v_and_b32 v27, v52, v19
  s_waitcnt vmcnt(6)
  s_nop 0
  v_mfma_f32_16x16x32_bf16 v[28:31], v[24:27], v[100:103], v[28:31]
  v_and_b32 v20, v53, v16
  v_and_b32 v21, v53, v17
  v_and_b32 v22, v33, v18
  v_and_b32 v23, v33, v19
  s_waitcnt vmcnt(5)
  s_nop 0
  v_mfma_f32_16x16x32_bf16 v[28:31], v[20:23], v[104:107], v[28:31]
  v_and_b32 v24, v33, v16
  v_and_b32 v25, v33, v17
  v_and_b32 v26, v53, v18
  v_and_b32 v27, v53, v19
  s_waitcnt vmcnt(4)
  s_nop 0
  v_mfma_f32_16x16x32_bf16 v[28:31], v[24:27], v[108:111], v[28:31]
  v_and_b32 v20, v54, v16
  v_and_b32 v21, v54, v17
  v_and_b32 v22, v34, v18
  v_and_b32 v23, v34, v19
  s_waitcnt vmcnt(3)
  s_nop 0
  v_mfma_f32_16x16x32_bf16 v[28:31], v[20:23], v[112:115], v[28:31]
  v_and_b32 v24, v34, v16
  v_and_b32 v25, v34, v17
  v_and_b32 v26, v54, v18
  v_and_b32 v27, v54, v19
  s_waitcnt vmcnt(2)
  s_nop 0
  v_mfma_f32_16x16x32_bf16 v[28:31], v[24:27], v[116:119], v[28:31]
  v_and_b32 v20, v55, v16
  v_and_b32 v21, v55, v17
  v_and_b32 v22, v35, v18
  v_and_b32 v23, v35, v19
  s_waitcnt vmcnt(1)
  s_nop 0
  v_mfma_f32_16x16x32_bf16 v[28:31], v[20:23], v[120:123], v[28:31]
  v_and_b32 v24, v35, v16
  v_and_b32 v25, v35, v17
  v_and_b32 v26, v55, v18
  v_and_b32 v27, v55, v19
  s_waitcnt vmcnt(0)
  s_nop 0
  v_mfma_f32_16x16x32_bf16 v[28:31], v[24:27], v[124:127], v[28:31]
  s_nop 7
  ds_write_b128 v15, v[28:31] offset:2048
  s_waitcnt lgkmcnt(0)
  s_cmp_ge_u32 s3, 4
  s_cbranch_scc1 L_A_fin
  s_load_dword s64, s[24:25], 192
  s_waitcnt lgkmcnt(0)
  s_cmp_lg_u32 s64, 0
  s_cbranch_scc1 L_drd_a
  v_mov_b32 v12, 0
L_dr_a:
  global_load_dword v13, v12, s[24:25] offset:192 sc1
  s_waitcnt vmcnt(0)
  v_readfirstlane_b32 s64, v13
  s_cmp_lg_u32 s64, 0
  s_cbranch_scc1 L_drd_a
  s_sleep 16
  s_add_u32 s62, s62, 1
  s_cmp_lt_u32 s62, 0x40000
  s_cbranch_scc1 L_dr_a
L_drd_a:
  s_lshr_b32 s63, s64, 2
  s_and_b32 s64, s64, 1
  s_lshr_b32 s31, s52, 1
  s_add_u32 s31, s31, s63
  s_and_b32 s31, s31, 7
  s_and_b32 s30, s31, 3
  s_lshl_b32 s30, s30, 1
  s_and_b32 s68, s52, 1
  s_or_b32 s30, s30, s68
  s_lshr_b32 s31, s31, 2
  s_lshr_b32 s68, s30, 1
  s_lshl_b32 s68, s68, 2
  s_and_b32 s69, s30, 1
  s_or_b32 s68, s68, s69
  s_xor_b32 s69, s31, s64
  s_lshl_b32 s69, s69, 1
  s_or_b32 s59, s68, s69
  s_lshl_b32 s59, s59, 12
  s_lshl_b32 s31, s53, 7
  s_add_u32 s59, s59, s31
  s_lshl_b32 s31, s3, 10
  s_add_u32 s59, s59, s31
  s_add_u32 s59, s59, 212992
  s_bfe_u32 s68, s59, 0x4000c
  s_lshl_b32 s68, s68, 23
  s_or_b32 s59, s59, s68
L_A_fin:
  s_barrier
  s_cmp_ge_u32 s3, 4
  s_cbranch_scc1 L_end
  ds_read_b128 v[64:67], v11 offset:2048
  ds_read_b128 v[68:71], v11 offset:3072
  ds_read_b128 v[72:75], v11 offset:4096
  ds_read_b128 v[76:79], v11 offset:5120
  s_waitcnt lgkmcnt(2)
  v_pk_add_f32 v[64:65], v[64:65], v[68:69]
  v_pk_add_f32 v[66:67], v[66:67], v[70:71]
  s_waitcnt lgkmcnt(0)
  v_pk_add_f32 v[72:73], v[72:73], v[76:77]
  v_pk_add_f32 v[74:75], v[74:75], v[78:79]
  v_pk_add_f32 v[64:65], v[64:65], v[72:73]
  v_pk_add_f32 v[66:67], v[66:67], v[74:75]
  s_nop 0
  v_permlane16_swap_b32 v64, v65
  v_permlane16_swap_b32 v66, v67
  v_add_f32 v64, v64, v65
  v_add_f32 v66, v66, v67
  s_nop 1
  v_permlane32_swap_b32 v64, v66
  v_add_f32 v64, v64, v66
  v_mov_b32 v65, v64
  s_nop 1
  v_permlane16_swap_b32 v64, v65
  v_cvt_pk_bf16_f32 v20, v64, v65
  s_mov_b32 exec_lo, 0xffff
  s_mov_b32 exec_hi, 0xffff
  v_min_u32 v20, -2, v20
  buffer_store_dword v20, v10, s[48:51], s59 offen
  s_waitcnt vmcnt(0)
  s_sleep 16
  buffer_store_dword v20, v10, s[48:51], s59 offen sc1
  s_endpgm
L_notA:
  s_cmp_ge_u32 s29, 25
  s_cbranch_scc0 L_Fmap
  s_sub_u32 s30, s29, 27
  s_cbranch_scc1 L_Qonly
  s_and_b32 s31, s28, 1
  s_mul_i32 s31, s31, 5
  s_add_u32 s57, s31, s30
  s_cmp_ge_u32 s57, 9
  s_cbranch_scc1 L_end
  s_lshr_b32 s53, s28, 1
  s_lshl_b32 s63, s30, 3
  s_add_u32 s63, s63, s28
  s_branch L_X
L_Qonly:
  s_sub_u32 s30, s29, 25
  s_lshl_b32 s31, s28, 3
  s_lshl_b32 s30, s30, 2
  s_add_u32 s30, s30, 3
  s_add_u32 s65, s30, s31
  s_mov_b32 s66, 1
  s_mov_b32 s67, 0
  s_mov_b32 s53, 0
  s_mov_b32 s52, 0
  s_branch L_F
L_Fmap:
  s_sub_u32 s52, s29, 16
  s_mov_b32 s67, 1
  s_lshl_b32 s30, s52, 3
  s_add_u32 s30, s30, s28
  s_cmp_ge_u32 s52, 3
  s_addc_u32 s65, s52, 0
  s_lshl_b32 s31, s28, 3
  s_add_u32 s65, s65, s31
  s_add_u32 s31, s30, 15
  s_mov_b32 s66, 1
  s_cmp_lt_u32 s52, 6
  s_cbranch_scc1 L_Fz
  s_mov_b32 s66, 0
  s_mov_b32 s65, 0
  s_sub_u32 s30, s30, 48
  s_lshl_b32 s53, s30, 3
  s_add_u32 s53, s53, 3
  s_cmp_lt_u32 s30, 9
  s_cbranch_scc1 L_F
  s_sub_u32 s31, s30, 9
L_Fz:
  s_mul_hi_u32 s30, s31, 0x24924925
  s_mul_i32 s53, s30, 7
  s_sub_u32 s31, s31, s53
  s_lshl_b32 s53, s30, 3
  s_cmp_ge_u32 s31, 3
  s_addc_u32 s53, s53, s31
L_F:
  s_cmp_ge_u32 s3, 8
  s_cbranch_scc0 L_F_ln
  s_setprio 2
  s_sub_u32 s57, s3, 8
  v_lshrrev_b32 v1, 3, v0
  v_bfe_u32 v3, v1, 1, 1
  s_and_b32 s30, s57, 1
  s_lshl_b32 s30, s30, 2
  v_mul_u32_u24 v3, 3, v3
  v_add_u32 v3, s30, v3
  v_and_b32 v2, 7, v0
  v_xor_b32 v2, v2, v3
  v_lshlrev_b32 v2, 4, v2
  s_lshl_b32 s30, s57, 3
  v_add_u32 v1, s30, v1
  v_lshl_add_u32 v4, v1, 13, v2
  v_mul_u32_u24 v5, 9216, v1
  v_add_u32 v5, v5, v2
  v_mul_u32_u24 v6, 1152, v1
  v_add_u32 v6, v6, v2
  s_lshl_b32 s58, s57, 10
  s_lshl_b32 s59, s65, 7
  s_sub_u32 s60, 4718592, s59
  s_waitcnt lgkmcnt(0)
  s_add_u32 s32, s10, s59
  s_addc_u32 s33, s11, 0
  s_mov_b32 s34, s60
  s_mov_b32 s35, 0x20000
  s_lshl_b32 s59, s53, 7
  s_sub_u32 s60, 5308416, s59
  s_add_u32 s36, s16, s59
  s_addc_u32 s37, s17, 0
  s_mov_b32 s38, s60
  s_mov_b32 s39, 0x20000
  s_cmp_eq_u32 s66, 0
  s_cbranch_scc1 L_F_ldg
  s_add_u32 m0, s58, 0
  s_mov_b32 s31, 0
  buffer_load_dwordx4 v4, s[32:35], s31 offen nt lds
  s_add_u32 m0, s58, 8192
  s_mov_b32 s31, 524288
  buffer_load_dwordx4 v4, s[32:35], s31 offen nt lds
  s_add_u32 m0, s58, 16384
  s_mov_b32 s31, 1048576
  buffer_load_dwordx4 v4, s[32:35], s31 offen nt lds
  s_add_u32 m0, s58, 24576
  s_mov_b32 s31, 1572864
  buffer_load_dwordx4 v4, s[32:35], s31 offen nt lds
  s_waitcnt vmcnt(3)
  s_add_u32 m0, s58, 32768
  s_mov_b32 s31, 2097152
  buffer_load_dwordx4 v4, s[32:35], s31 offen nt lds
  s_waitcnt vmcnt(3)
  s_add_u32 m0, s58, 40960
  s_mov_b32 s31, 2621440
  buffer_load_dwordx4 v4, s[32:35], s31 offen nt lds
  s_waitcnt vmcnt(3)
  s_add_u32 m0, s58, 49152
  s_mov_b32 s31, 3145728
  buffer_load_dwordx4 v4, s[32:35], s31 offen nt lds
  s_waitcnt vmcnt(3)
  s_add_u32 m0, s58, 57344
  s_mov_b32 s31, 3670016
  buffer_load_dwordx4 v4, s[32:35], s31 offen nt lds
  s_waitcnt vmcnt(3)
  s_add_u32 m0, s58, 65536
  s_mov_b32 s31, 4194304
  buffer_load_dwordx4 v4, s[32:35], s31 offen nt lds
  s_cmp_lg_u32 s67, 0
  s_cbranch_scc1 L_F_ldg
  s_waitcnt vmcnt(0)
  s_barrier
  s_endpgm
L_F_ldg:
  s_setprio 0
  s_add_u32 s40, s18, s59
  s_addc_u32 s41, s19, 0
  s_mov_b32 s42, s60
  s_mov_b32 s43, 0x20000
  s_mul_i32 s59, s28, 589824
  s_lshl_b32 s30, s52, 7
  s_add_u32 s59, s59, s30
  s_sub_u32 s60, 4718592, s59
  s_add_u32 s44, s12, s59
  s_addc_u32 s45, s13, 0
  s_mov_b32 s46, s60
  s_mov_b32 s47, 0x20000
  s_cmp_eq_u32 s66, 0
  s_cbranch_scc1 L_F_ldg2
  s_add_u32 m0, s58, 73728
  s_mov_b32 s31, 0
  buffer_load_dwordx4 v5, s[36:39], s31 offen nt lds
  s_waitcnt vmcnt(1)
  s_barrier
  s_barrier
  s_barrier
  s_waitcnt vmcnt(1)
  s_add_u32 m0, s58, 81920
  s_mov_b32 s31, 589824
  buffer_load_dwordx4 v5, s[36:39], s31 offen nt lds
  s_waitcnt vmcnt(1)
  s_add_u32 m0, s58, 90112
  s_mov_b32 s31, 1179648
  buffer_load_dwordx4 v5, s[36:39], s31 offen nt lds
  s_waitcnt vmcnt(1)
  s_add_u32 m0, s58, 98304
  s_mov_b32 s31, 1769472
  buffer_load_dwordx4 v5, s[36:39], s31 offen nt lds
  s_waitcnt vmcnt(1)
  s_add_u32 m0, s58, 106496
  s_mov_b32 s31, 2359296
  buffer_load_dwordx4 v5, s[36:39], s31 offen nt lds
  s_waitcnt vmcnt(1)
  s_add_u32 m0, s58, 114688
  s_mov_b32 s31, 2949120
  buffer_load_dwordx4 v5, s[36:39], s31 offen nt lds
  s_waitcnt vmcnt(1)
  s_add_u32 m0, s58, 122880
  s_mov_b32 s31, 3538944
  buffer_load_dwordx4 v5, s[36:39], s31 offen nt lds
  s_waitcnt vmcnt(1)
  s_add_u32 m0, s58, 131072
  s_mov_b32 s31, 4128768
  buffer_load_dwordx4 v5, s[36:39], s31 offen nt lds
  s_waitcnt vmcnt(1)
  s_add_u32 m0, s58, 139264
  s_mov_b32 s31, 4718592
  buffer_load_dwordx4 v5, s[36:39], s31 offen nt lds
  s_branch L_F_ldu
L_F_ldg2:
  s_waitcnt vmcnt(0)
  s_add_u32 m0, s58, 73728
  s_mov_b32 s31, 0
  buffer_load_dwordx4 v5, s[36:39], s31 offen nt lds
  s_waitcnt vmcnt(0)
  s_add_u32 m0, s58, 81920
  s_mov_b32 s31, 589824
  buffer_load_dwordx4 v5, s[36:39], s31 offen nt lds
  s_waitcnt vmcnt(0)
  s_add_u32 m0, s58, 90112
  s_mov_b32 s31, 1179648
  buffer_load_dwordx4 v5, s[36:39], s31 offen nt lds
  s_waitcnt vmcnt(0)
  s_add_u32 m0, s58, 98304
  s_mov_b32 s31, 1769472
  buffer_load_dwordx4 v5, s[36:39], s31 offen nt lds
  s_waitcnt vmcnt(0)
  s_add_u32 m0, s58, 106496
  s_mov_b32 s31, 2359296
  buffer_load_dwordx4 v5, s[36:39], s31 offen nt lds
  s_waitcnt vmcnt(0)
  s_add_u32 m0, s58, 114688
  s_mov_b32 s31, 2949120
  buffer_load_dwordx4 v5, s[36:39], s31 offen nt lds
  s_waitcnt vmcnt(0)
  s_add_u32 m0, s58, 122880
  s_mov_b32 s31, 3538944
  buffer_load_dwordx4 v5, s[36:39], s31 offen nt lds
  s_waitcnt vmcnt(0)
  s_add_u32 m0, s58, 131072
  s_mov_b32 s31, 4128768
  buffer_load_dwordx4 v5, s[36:39], s31 offen nt lds
  s_waitcnt vmcnt(0)
  s_add_u32 m0, s58, 139264
  s_mov_b32 s31, 4718592
  buffer_load_dwordx4 v5, s[36:39], s31 offen nt lds
  s_barrier
  s_barrier
L_F_ldu:
  s_waitcnt vmcnt(1)
  s_add_u32 m0, s58, 0
  s_mov_b32 s31, 0
  buffer_load_dwordx4 v5, s[40:43], s31 offen nt lds
  s_waitcnt vmcnt(1)
  s_barrier
  s_waitcnt vmcnt(1)
  s_add_u32 m0, s58, 8192
  s_mov_b32 s31, 589824
  buffer_load_dwordx4 v5, s[40:43], s31 offen nt lds
  s_waitcnt vmcnt(1)
  s_add_u32 m0, s58, 16384
  s_mov_b32 s31, 1179648
  buffer_load_dwordx4 v5, s[40:43], s31 offen nt lds
  s_waitcnt vmcnt(1)
  s_add_u32 m0, s58, 24576
  s_mov_b32 s31, 1769472
  buffer_load_dwordx4 v5, s[40:43], s31 offen nt lds
  s_waitcnt vmcnt(1)
  s_add_u32 m0, s58, 32768
  s_mov_b32 s31, 2359296
  buffer_load_dwordx4 v5, s[40:43], s31 offen nt lds
  s_waitcnt vmcnt(1)
  s_add_u32 m0, s58, 40960
  s_mov_b32 s31, 2949120
  buffer_load_dwordx4 v5, s[40:43], s31 offen nt lds
  s_waitcnt vmcnt(1)
  s_add_u32 m0, s58, 49152
  s_mov_b32 s31, 3538944
  buffer_load_dwordx4 v5, s[40:43], s31 offen nt lds
  s_waitcnt vmcnt(1)
  s_add_u32 m0, s58, 57344
  s_mov_b32 s31, 4128768
  buffer_load_dwordx4 v5, s[40:43], s31 offen nt lds
  s_waitcnt vmcnt(1)
  s_add_u32 m0, s58, 65536
  s_mov_b32 s31, 4718592
  buffer_load_dwordx4 v5, s[40:43], s31 offen nt lds
  s_barrier
  s_waitcnt vmcnt(0)
  s_barrier
  s_barrier
  s_barrier
  s_waitcnt vmcnt(2)
  s_add_u32 m0, s58, 73728
  s_mov_b32 s31, 0
  buffer_load_dwordx4 v6, s[44:47], s31 offen nt lds
  s_waitcnt vmcnt(2)
  s_add_u32 m0, s58, 81920
  s_mov_b32 s31, 73728
  buffer_load_dwordx4 v6, s[44:47], s31 offen nt lds
  s_waitcnt vmcnt(2)
  s_add_u32 m0, s58, 90112
  s_mov_b32 s31, 147456
  buffer_load_dwordx4 v6, s[44:47], s31 offen nt lds
  s_waitcnt vmcnt(2)
  s_add_u32 m0, s58, 98304
  s_mov_b32 s31, 221184
  buffer_load_dwordx4 v6, s[44:47], s31 offen nt lds
  s_waitcnt vmcnt(2)
  s_add_u32 m0, s58, 106496
  s_mov_b32 s31, 294912
  buffer_load_dwordx4 v6, s[44:47], s31 offen nt lds
  s_waitcnt vmcnt(2)
  s_add_u32 m0, s58, 114688
  s_mov_b32 s31, 368640
  buffer_load_dwordx4 v6, s[44:47], s31 offen nt lds
  s_waitcnt vmcnt(2)
  s_add_u32 m0, s58, 122880
  s_mov_b32 s31, 442368
  buffer_load_dwordx4 v6, s[44:47], s31 offen nt lds
  s_waitcnt vmcnt(2)
  s_add_u32 m0, s58, 131072
  s_mov_b32 s31, 516096
  buffer_load_dwordx4 v6, s[44:47], s31 offen nt lds
  s_mov_b32 s48, s26
  s_mov_b32 s49, s27
  s_mov_b32 s50, 268435456
  s_mov_b32 s51, 0x20000
  s_load_dword s64, s[24:25], 192
  s_waitcnt lgkmcnt(0)
  s_cmp_lg_u32 s64, 0
  s_cbranch_scc1 L_drd_l
  v_mov_b32 v12, 0
L_dr_l:
  global_load_dword v13, v12, s[24:25] offset:192 sc1
  s_waitcnt vmcnt(0)
  v_readfirstlane_b32 s64, v13
  s_cmp_lg_u32 s64, 0
  s_cbranch_scc1 L_drd_l
  s_sleep 16
  s_add_u32 s62, s62, 1
  s_cmp_lt_u32 s62, 0x40000
  s_cbranch_scc1 L_dr_l
L_drd_l:
  s_lshr_b32 s63, s64, 2
  s_and_b32 s64, s64, 1
  s_lshl_b32 s42, s28, 1
  s_lshr_b32 s43, s57, 2
  s_add_u32 s43, s43, s42
  s_lshr_b32 s31, s43, 1
  s_add_u32 s31, s31, s63
  s_and_b32 s31, s31, 7
  s_and_b32 s30, s31, 3
  s_lshl_b32 s30, s30, 1
  s_and_b32 s68, s43, 1
  s_or_b32 s30, s30, s68
  s_lshr_b32 s31, s31, 2
  s_lshr_b32 s68, s30, 1
  s_lshl_b32 s68, s68, 2
  s_and_b32 s69, s30, 1
  s_or_b32 s68, s68, s69
  s_xor_b32 s69, s31, s64
  s_lshl_b32 s69, s69, 1
  s_or_b32 s42, s68, s69
  s_lshl_b32 s42, s42, 12
  s_and_b32 s30, s58, 0xc00
  s_add_u32 s42, s42, s30
  s_add_u32 s42, s42, 212992
  s_bfe_u32 s68, s42, 0x4000c
  s_lshl_b32 s68, s68, 23
  s_or_b32 s42, s42, s68
  v_lshlrev_b32 v2, 4, v0
  s_add_u32 s30, s58, 147456
  v_add_u32 v3, s30, v2
  s_waitcnt vmcnt(0)
  s_barrier
L_op:
  buffer_load_dwordx4 v[8:11], v2, s[48:51], s42 offen sc1
  s_waitcnt vmcnt(0)
  v_max3_u32 v12, v8, v9, v10
  v_max_u32 v12, v12, v11
  v_cmp_eq_u32 vcc, -1, v12
  s_cbranch_vccz L_og
  s_mov_b64 exec, vcc
  s_bcnt1_i32_b64 s30, vcc
  s_cmp_le_u32 s30, 24
  s_cbranch_scc1 L_ons
  s_sleep 6
  s_cmp_le_u32 s30, 64
  s_cbranch_scc1 L_ons
  s_sleep 16
L_ons:
  s_add_u32 s62, s62, 1
  s_cmp_lt_u32 s62, 0x40000
  s_cbranch_scc1 L_op
L_og:
  s_mov_b64 exec, -1
  ds_write_b128 v3, v[8:11]
  s_waitcnt lgkmcnt(0)
  s_barrier
  s_endpgm
L_F_ln:
  s_setprio 3
  s_mul_i32 s57, s3, 1152
  v_lshlrev_b32 v1, 5, v0
  v_mov_b32 v32, 0
  v_mov_b32 v33, 0
  s_waitcnt lgkmcnt(0)
  s_mov_b32 s32, s4
  s_mov_b32 s33, s5
  s_mov_b32 s34, 9216
  s_mov_b32 s35, 0x20000
  s_mov_b32 exec_hi, 0xf
  buffer_load_dwordx4 v[8:11], v1, s[32:35], s57 offen
  buffer_load_dwordx4 v[12:15], v1, s[32:35], s57 offen offset:16
  s_mov_b64 exec, -1
  s_mov_b32 s48, s26
  s_mov_b32 s49, s27
  s_mov_b32 s50, 268435456
  s_mov_b32 s51, 0x20000
  s_lshl_b32 s30, s3, 4
  s_add_u32 s30, s30, 147456
  v_lshlrev_b32 v2, 8, v0
  v_add_u32 v2, s30, v2
  s_mov_b32 s31, 0x3ae38e39
  s_mov_b32 exec_hi, 0xf
  s_waitcnt vmcnt(0)
  s_setprio 0
  v_lshlrev_b32 v16, 16, v8
  v_and_b32 v17, 0xffff0000, v8
  v_lshlrev_b32 v18, 16, v9
  v_and_b32 v19, 0xffff0000, v9
  v_lshlrev_b32 v20, 16, v10
  v_and_b32 v21, 0xffff0000, v10
  v_lshlrev_b32 v22, 16, v11
  v_and_b32 v23, 0xffff0000, v11
  v_lshlrev_b32 v24, 16, v12
  v_and_b32 v25, 0xffff0000, v12
  v_lshlrev_b32 v26, 16, v13
  v_and_b32 v27, 0xffff0000, v13
  v_lshlrev_b32 v28, 16, v14
  v_and_b32 v29, 0xffff0000, v14
  v_lshlrev_b32 v30, 16, v15
  v_and_b32 v31, 0xffff0000, v15
  v_add_f32 v32, v16, v17
  v_add_f32 v32, v32, v18
  v_add_f32 v32, v32, v19
  v_add_f32 v32, v32, v20
  v_add_f32 v32, v32, v21
  v_add_f32 v32, v32, v22
  v_add_f32 v32, v32, v23
  v_add_f32 v32, v32, v24
  v_add_f32 v32, v32, v25
  v_add_f32 v32, v32, v26
  v_add_f32 v32, v32, v27
  v_add_f32 v32, v32, v28
  v_add_f32 v32, v32, v29
  v_add_f32 v32, v32, v30
  v_add_f32 v32, v32, v31
  s_mov_b64 exec, -1
  s_nop 1
  v_add_f32_dpp v32, v32, v32 quad_perm:[1,0,3,2] row_mask:0xf bank_mask:0xf
  s_nop 1
  v_add_f32_dpp v32, v32, v32 quad_perm:[2,3,0,1] row_mask:0xf bank_mask:0xf
  s_nop 1
  v_add_f32_dpp v32, v32, v32 row_half_mirror row_mask:0xf bank_mask:0xf
  s_nop 1
  v_add_f32_dpp v32, v32, v32 row_mirror row_mask:0xf bank_mask:0xf
  v_mov_b32 v34, v32
  s_nop 1
  v_permlane16_swap_b32 v32, v34
  v_add_f32 v32, v32, v34
  v_mov_b32 v34, v32
  s_nop 1
  v_permlane32_swap_b32 v32, v34
  v_add_f32 v32, v32, v34
  v_mul_f32 v32, s31, v32
  s_mov_b32 exec_hi, 0xf
  v_sub_f32 v34, v16, v32
  v_fmac_f32 v33, v34, v34
  v_sub_f32 v34, v17, v32
  v_fmac_f32 v33, v34, v34
  v_sub_f32 v34, v18, v32
  v_fmac_f32 v33, v34, v34
  v_sub_f32 v34, v19, v32
  v_fmac_f32 v33, v34, v34
  v_sub_f32 v34, v20, v32
  v_fmac_f32 v33, v34, v34
  v_sub_f32 v34, v21, v32
  v_fmac_f32 v33, v34, v34
  v_sub_f32 v34, v22, v32
  v_fmac_f32 v33, v34, v34
  v_sub_f32 v34, v23, v32
  v_fmac_f32 v33, v34, v34
  v_sub_f32 v34, v24, v32
  v_fmac_f32 v33, v34, v34
  v_sub_f32 v34, v25, v32
  v_fmac_f32 v33, v34, v34
  v_sub_f32 v34, v26, v32
  v_fmac_f32 v33, v34, v34
  v_sub_f32 v34, v27, v32
  v_fmac_f32 v33, v34, v34
  v_sub_f32 v34, v28, v32
  v_fmac_f32 v33, v34, v34
  v_sub_f32 v34, v29, v32
  v_fmac_f32 v33, v34, v34
  v_sub_f32 v34, v30, v32
  v_fmac_f32 v33, v34, v34
  v_sub_f32 v34, v31, v32
  v_fmac_f32 v33, v34, v34
  s_mov_b64 exec, -1
  s_nop 1
  v_add_f32_dpp v33, v33, v33 quad_perm:[1,0,3,2] row_mask:0xf bank_mask:0xf
  s_nop 1
  v_add_f32_dpp v33, v33, v33 quad_perm:[2,3,0,1] row_mask:0xf bank_mask:0xf
  s_nop 1
  v_add_f32_dpp v33, v33, v33 row_half_mirror row_mask:0xf bank_mask:0xf
  s_nop 1
  v_add_f32_dpp v33, v33, v33 row_mirror row_mask:0xf bank_mask:0xf
  v_mov_b32 v34, v33
  s_nop 1
  v_permlane16_swap_b32 v33, v34
  v_add_f32 v33, v33, v34
  v_mov_b32 v34, v33
  s_nop 1
  v_permlane32_swap_b32 v33, v34
  v_add_f32 v33, v33, v34
  v_mul_f32 v33, s31, v33
  v_cvt_pk_bf16_f32 v32, v32, v32
  v_and_b32 v32, 0xffff0000, v32
  v_cvt_pk_bf16_f32 v33, v33, v33
  v_and_b32 v33, 0xffff0000, v33
  v_add_f32 v33, 0x3727c5ac, v33
  v_cvt_pk_bf16_f32 v33, v33, v33
  v_and_b32 v33, 0xffff0000, v33
  v_sqrt_f32 v33, v33
  s_nop 0
  v_cvt_pk_bf16_f32 v33, v33, v33
  v_and_b32 v33, 0xffff0000, v33
  v_rcp_f32 v33, v33
  v_sub_f32 v16, v16, v32
  v_sub_f32 v17, v17, v32
  v_sub_f32 v18, v18, v32
  v_sub_f32 v19, v19, v32
  v_sub_f32 v20, v20, v32
  v_sub_f32 v21, v21, v32
  v_sub_f32 v22, v22, v32
  v_sub_f32 v23, v23, v32
  v_sub_f32 v24, v24, v32
  v_sub_f32 v25, v25, v32
  v_sub_f32 v26, v26, v32
  v_sub_f32 v27, v27, v32
  v_sub_f32 v28, v28, v32
  v_sub_f32 v29, v29, v32
  v_sub_f32 v30, v30, v32
  v_sub_f32 v31, v31, v32
  v_cvt_pk_bf16_f32 v34, v16, v17
  v_lshlrev_b32 v16, 16, v34
  v_and_b32 v17, 0xffff0000, v34
  v_cvt_pk_bf16_f32 v34, v18, v19
  v_lshlrev_b32 v18, 16, v34
  v_and_b32 v19, 0xffff0000, v34
  v_cvt_pk_bf16_f32 v34, v20, v21
  v_lshlrev_b32 v20, 16, v34
  v_and_b32 v21, 0xffff0000, v34
  v_cvt_pk_bf16_f32 v34, v22, v23
  v_lshlrev_b32 v22, 16, v34
  v_and_b32 v23, 0xffff0000, v34
  v_cvt_pk_bf16_f32 v34, v24, v25
  v_lshlrev_b32 v24, 16, v34
  v_and_b32 v25, 0xffff0000, v34
  v_cvt_pk_bf16_f32 v34, v26, v27
  v_lshlrev_b32 v26, 16, v34
  v_and_b32 v27, 0xffff0000, v34
  v_cvt_pk_bf16_f32 v34, v28, v29
  v_lshlrev_b32 v28, 16, v34
  v_and_b32 v29, 0xffff0000, v34
  v_cvt_pk_bf16_f32 v34, v30, v31
  v_lshlrev_b32 v30, 16, v34
  v_and_b32 v31, 0xffff0000, v34
  v_mul_f32 v16, v33, v16
  v_mul_f32 v17, v33, v17
  v_mul_f32 v18, v33, v18
  v_mul_f32 v19, v33, v19
  v_mul_f32 v20, v33, v20
  v_mul_f32 v21, v33, v21
  v_mul_f32 v22, v33, v22
  v_mul_f32 v23, v33, v23
  v_mul_f32 v24, v33, v24
  v_mul_f32 v25, v33, v25
  v_mul_f32 v26, v33, v26
  v_mul_f32 v27, v33, v27
  v_mul_f32 v28, v33, v28
  v_mul_f32 v29, v33, v29
  v_mul_f32 v30, v33, v30
  v_mul_f32 v31, v33, v31
  v_cvt_pk_bf16_f32 v8, v16, v17
  v_cvt_pk_bf16_f32 v9, v18, v19
  v_cvt_pk_bf16_f32 v10, v20, v21
  v_cvt_pk_bf16_f32 v11, v22, v23
  v_cvt_pk_bf16_f32 v12, v24, v25
  v_cvt_pk_bf16_f32 v13, v26, v27
  v_cvt_pk_bf16_f32 v14, v28, v29
  v_cvt_pk_bf16_f32 v15, v30, v31
  s_mov_b32 exec_hi, 0xf
  ds_write_b128 v2, v[8:11]
  ds_write_b128 v2, v[12:15] offset:128
  s_mov_b64 exec, -1
  v_lshrrev_b32 v3, 4, v0
  v_bfe_u32 v4, v0, 2, 2
  v_lshl_add_u32 v2, v3, 3, v4
  v_lshlrev_b32 v2, 7, v2
  v_and_b32 v3, 1, v3
  v_lshlrev_b32 v3, 2, v3
  v_lshrrev_b32 v4, 1, v4
  v_mad_u32_u24 v3, v4, 3, v3
  v_bfe_u32 v4, v0, 1, 1
  s_lshl_b32 s30, s3, 1
  v_add_u32 v4, s30, v4
  v_xor_b32 v3, v3, v4
  v_lshl_add_u32 v2, v3, 4, v2
  v_and_b32 v3, 1, v0
  v_lshl_add_u32 v2, v3, 3, v2
  v_add_u32 v3, 36864, v2
  v_add_u32 v4, 73728, v2
  v_add_u32 v5, 110592, v2
  v_and_b32 v6, 7, v0
  v_lshrrev_b32 v7, 4, v0
  v_lshlrev_b32 v1, 4, v6
  v_lshl_add_u32 v1, v7, 7, v1
  v_add_u32 v1, 147456, v1
  v_lshlrev_b32 v6, 7, v6
  s_lshl_b32 s30, s3, 5
  v_lshl_add_u32 v6, v7, 3, v6
  s_add_u32 s30, s30, 156736
  v_add_u32 v6, s30, v6
  v_lshlrev_b32 v7, 4, v0
  v_add_u32 v7, 156736, v7
  s_lshl_b32 s42, s65, 10
  s_lshl_b32 s43, s53, 10
  s_add_u32 s43, s43, 65536
  s_bfe_u32 s68, s42, 0x4000c
  s_lshl_b32 s68, s68, 23
  s_or_b32 s42, s42, s68
  s_bfe_u32 s68, s43, 0x4000c
  s_lshl_b32 s68, s68, 23
  s_or_b32 s43, s43, s68
  v_mov_b32 v20, 156672
  v_mov_b32 v21, 0
  ds_write_b32 v20, v21
  s_waitcnt lgkmcnt(0)
  s_barrier
  s_cmp_lt_u32 s3, 4
  s_cbranch_scc1 L_F_cmp
  s_cmp_lg_u32 s3, 4
  s_cbranch_scc1 L_end
  s_load_dword s30, s[24:25], 0
  s_waitcnt lgkmcnt(0)
  s_cmp_ge_u32 s30, 13
  s_cbranch_scc1 L_ccd_f
  s_sleep 20
  s_load_dword s30, s[24:25], 64
  s_waitcnt lgkmcnt(0)
  s_cmp_ge_u32 s30, 13
  s_cbranch_scc1 L_ccd_f
  s_sleep 20
  s_load_dword s30, s[24:25], 128
  s_waitcnt lgkmcnt(0)
  s_cmp_ge_u32 s30, 13
  s_cbranch_scc1 L_ccd_f
  s_sleep 20
  v_mov_b32 v12, 0
L_cc_f:
  global_load_dword v13, v12, s[24:25] sc1
  s_waitcnt vmcnt(0)
  v_readfirstlane_b32 s30, v13
  s_cmp_ge_u32 s30, 13
  s_cbranch_scc1 L_ccd_f
  s_sleep 16
  s_add_u32 s62, s62, 1
  s_cmp_lt_u32 s62, 0x40000
  s_cbranch_scc1 L_cc_f
L_ccd_f:
  v_mov_b32 v21, 1
  ds_write_b32 v20, v21
  s_waitcnt lgkmcnt(0)
  s_endpgm
L_F_cmp:
  s_cmp_eq_u32 s66, 0
  s_cbranch_scc1 L_F_noq
  ds_read_b128 v[56:59], v1 offset:0
  ds_read_b64_tr_b16 v[24:25], v2 offset:0
  ds_read_b64_tr_b16 v[26:27], v2 offset:512
  ds_read_b128 v[60:63], v1 offset:512
  ds_read_b64_tr_b16 v[28:29], v2 offset:4096
  ds_read_b64_tr_b16 v[30:31], v2 offset:4608
  ds_read_b128 v[64:67], v1 offset:1024
  ds_read_b64_tr_b16 v[32:33], v2 offset:8192
  ds_read_b64_tr_b16 v[34:35], v2 offset:8704
  ds_read_b128 v[68:71], v1 offset:1536
  ds_read_b64_tr_b16 v[36:37], v2 offset:12288
  ds_read_b64_tr_b16 v[38:39], v2 offset:12800
  ds_read_b128 v[72:75], v1 offset:2048
  ds_read_b64_tr_b16 v[40:41], v2 offset:16384
  ds_read_b64_tr_b16 v[42:43], v2 offset:16896
  s_waitcnt lgkmcnt(12)
  v_mfma_f32_16x16x32_bf16 v[8:11], v[24:27], v[56:59], 0
  ds_read_b128 v[76:79], v1 offset:2560
  ds_read_b64_tr_b16 v[24:25], v2 offset:20480
  ds_read_b64_tr_b16 v[26:27], v2 offset:20992
  s_waitcnt lgkmcnt(12)
  v_mfma_f32_16x16x32_bf16 v[8:11], v[28:31], v[60:63], v[8:11]
  ds_read_b128 v[80:83], v1 offset:3072
  ds_read_b64_tr_b16 v[28:29], v2 offset:24576
  ds_read_b64_tr_b16 v[30:31], v2 offset:25088
  s_waitcnt lgkmcnt(12)
  v_mfma_f32_16x16x32_bf16 v[8:11], v[32:35], v[64:67], v[8:11]
  ds_read_b128 v[84:87], v1 offset:3584
  ds_read_b64_tr_b16 v[32:33], v2 offset:28672
  ds_read_b64_tr_b16 v[34:35], v2 offset:29184
  s_waitcnt lgkmcnt(12)
  v_mfma_f32_16x16x32_bf16 v[8:11], v[36:39], v[68:71], v[8:11]
  ds_read_b128 v[88:91], v1 offset:4096
  ds_read_b64_tr_b16 v[36:37], v2 offset:32768
  ds_read_b64_tr_b16 v[38:39], v2 offset:33280
  s_waitcnt lgkmcnt(12)
  v_mfma_f32_16x16x32_bf16 v[8:11], v[40:43], v[72:75], v[8:11]
  ds_read_b128 v[92:95], v1 offset:4608
  ds_read_b64_tr_b16 v[40:41], v3 offset:0
  ds_read_b64_tr_b16 v[42:43], v3 offset:512
  s_waitcnt lgkmcnt(12)
  v_mfma_f32_16x16x32_bf16 v[8:11], v[24:27], v[76:79], v[8:11]
  ds_read_b128 v[96:99], v1 offset:5120
  ds_read_b64_tr_b16 v[24:25], v3 offset:4096
  ds_read_b64_tr_b16 v[26:27], v3 offset:4608
  s_waitcnt lgkmcnt(12)
  v_mfma_f32_16x16x32_bf16 v[8:11], v[28:31], v[80:83], v[8:11]
  ds_read_b128 v[100:103], v1 offset:5632
  ds_read_b64_tr_b16 v[28:29], v3 offset:8192
  ds_read_b64_tr_b16 v[30:31], v3 offset:8704
  s_waitcnt lgkmcnt(12)
  v_mfma_f32_16x16x32_bf16 v[8:11], v[32:35], v[84:87], v[8:11]
  ds_read_b128 v[104:107], v1 offset:6144
  ds_read_b64_tr_b16 v[32:33], v3 offset:12288
  ds_read_b64_tr_b16 v[34:35], v3 offset:12800
  s_waitcnt lgkmcnt(12)
  v_mfma_f32_16x16x32_bf16 v[8:11], v[36:39], v[88:91], v[8:11]
  ds_read_b128 v[108:111], v1 offset:6656
  ds_read_b64_tr_b16 v[36:37], v3 offset:16384
  ds_read_b64_tr_b16 v[38:39], v3 offset:16896
  s_waitcnt lgkmcnt(12)
  v_mfma_f32_16x16x32_bf16 v[8:11], v[40:43], v[92:95], v[8:11]
  ds_read_b128 v[112:115], v1 offset:7168
  ds_read_b64_tr_b16 v[40:41], v3 offset:20480
  ds_read_b64_tr_b16 v[42:43], v3 offset:20992
  s_waitcnt lgkmcnt(12)
  v_mfma_f32_16x16x32_bf16 v[8:11], v[24:27], v[96:99], v[8:11]
  ds_read_b128 v[116:119], v1 offset:7680
  ds_read_b64_tr_b16 v[24:25], v3 offset:24576
  ds_read_b64_tr_b16 v[26:27], v3 offset:25088
  s_waitcnt lgkmcnt(12)
  v_mfma_f32_16x16x32_bf16 v[8:11], v[28:31], v[100:103], v[8:11]
  ds_read_b128 v[120:123], v1 offset:8192
  ds_read_b64_tr_b16 v[28:29], v3 offset:28672
  ds_read_b64_tr_b16 v[30:31], v3 offset:29184
  s_waitcnt lgkmcnt(12)
  v_mfma_f32_16x16x32_bf16 v[8:11], v[32:35], v[104:107], v[8:11]
  ds_read_b128 v[124:127], v1 offset:8704
  ds_read_b64_tr_b16 v[32:33], v3 offset:32768
  ds_read_b64_tr_b16 v[34:35], v3 offset:33280
  s_waitcnt lgkmcnt(12)
  v_mfma_f32_16x16x32_bf16 v[8:11], v[36:39], v[108:111], v[8:11]
  s_waitcnt lgkmcnt(9)
  v_mfma_f32_16x16x32_bf16 v[8:11], v[40:43], v[112:115], v[8:11]
  s_waitcnt lgkmcnt(6)
  v_mfma_f32_16x16x32_bf16 v[8:11], v[24:27], v[116:119], v[8:11]
  s_waitcnt lgkmcnt(3)
  v_mfma_f32_16x16x32_bf16 v[8:11], v[28:31], v[120:123], v[8:11]
  s_waitcnt lgkmcnt(0)
  v_mfma_f32_16x16x32_bf16 v[8:11], v[32:35], v[124:127], v[8:11]
L_F_fwq:
  ds_read_b32 v21, v20
  s_waitcnt lgkmcnt(0)
  v_readfirstlane_b32 s30, v21
  s_cmp_lg_u32 s30, 0
  s_cbranch_scc1 L_F_fwdq
  s_sleep 2
  s_add_u32 s62, s62, 1
  s_cmp_lt_u32 s62, 0x40000
  s_cbranch_scc1 L_F_fwq
L_F_fwdq:
  s_nop 3
  v_cvt_pk_bf16_f32 v12, v8, v9
  v_cvt_pk_bf16_f32 v13, v10, v11
  v_min_u32 v12, -2, v12
  v_min_u32 v13, -2, v13
  s_mov_b32 exec_lo, 0x00ff00ff
  s_mov_b32 exec_hi, 0x00ff00ff
  ds_write_b64 v6, v[12:13]
  s_mov_b64 exec, -1
  s_waitcnt lgkmcnt(0)
  s_barrier
  s_cmp_lg_u32 s3, 0
  s_cbranch_scc1 L_pb_q
  ds_read_b128 v[12:15], v7
  v_lshlrev_b32 v21, 4, v0
  s_waitcnt lgkmcnt(0)
  buffer_store_dwordx4 v[12:15], v21, s[48:51], s42 offen sc1
L_pb_q:
  s_cmp_eq_u32 s67, 0
  s_cbranch_scc1 L_end
  s_branch L_F_g
L_F_noq:
  ds_read_b128 v[56:59], v1 offset:0
  ds_read_b128 v[60:63], v1 offset:512
  ds_read_b128 v[64:67], v1 offset:1024
  ds_read_b128 v[68:71], v1 offset:1536
  ds_read_b128 v[72:75], v1 offset:2048
  ds_read_b128 v[76:79], v1 offset:2560
  ds_read_b128 v[80:83], v1 offset:3072
  ds_read_b128 v[84:87], v1 offset:3584
  ds_read_b128 v[88:91], v1 offset:4096
  ds_read_b128 v[92:95], v1 offset:4608
  ds_read_b128 v[96:99], v1 offset:5120
  ds_read_b128 v[100:103], v1 offset:5632
  s_waitcnt lgkmcnt(6)
  ds_read_b128 v[104:107], v1 offset:6144
  ds_read_b128 v[108:111], v1 offset:6656
  ds_read_b128 v[112:115], v1 offset:7168
  ds_read_b128 v[116:119], v1 offset:7680
  ds_read_b128 v[120:123], v1 offset:8192
  ds_read_b128 v[124:127], v1 offset:8704
L_F_fwn:
  ds_read_b32 v21, v20
  s_waitcnt lgkmcnt(0)
  v_readfirstlane_b32 s30, v21
  s_cmp_lg_u32 s30, 0
  s_cbranch_scc1 L_F_fwdn
  s_sleep 2
  s_add_u32 s62, s62, 1
  s_cmp_lt_u32 s62, 0x40000
  s_cbranch_scc1 L_F_fwn
L_F_fwdn:
L_F_g:
  s_barrier
  s_barrier
  ds_read_b64_tr_b16 v[24:25], v4 offset:0
  ds_read_b64_tr_b16 v[26:27], v4 offset:512
  ds_read_b64_tr_b16 v[28:29], v4 offset:4096
  ds_read_b64_tr_b16 v[30:31], v4 offset:4608
  ds_read_b64_tr_b16 v[32:33], v4 offset:8192
  ds_read_b64_tr_b16 v[34:35], v4 offset:8704
  ds_read_b64_tr_b16 v[36:37], v4 offset:12288
  ds_read_b64_tr_b16 v[38:39], v4 offset:12800
  ds_read_b64_tr_b16 v[40:41], v4 offset:16384
  ds_read_b64_tr_b16 v[42:43], v4 offset:16896
  ds_read_b64_tr_b16 v[44:45], v4 offset:20480
  ds_read_b64_tr_b16 v[46:47], v4 offset:20992
  s_waitcnt lgkmcnt(10)
  v_mfma_f32_16x16x32_bf16 v[8:11], v[24:27], v[56:59], 0
  ds_read_b64_tr_b16 v[24:25], v4 offset:24576
  ds_read_b64_tr_b16 v[26:27], v4 offset:25088
  s_waitcnt lgkmcnt(10)
  v_mfma_f32_16x16x32_bf16 v[8:11], v[28:31], v[60:63], v[8:11]
  ds_read_b64_tr_b16 v[28:29], v4 offset:28672
  ds_read_b64_tr_b16 v[30:31], v4 offset:29184
  s_waitcnt lgkmcnt(10)
  v_mfma_f32_16x16x32_bf16 v[8:11], v[32:35], v[64:67], v[8:11]
  ds_read_b64_tr_b16 v[32:33], v4 offset:32768
  ds_read_b64_tr_b16 v[34:35], v4 offset:33280
  s_waitcnt lgkmcnt(10)
  v_mfma_f32_16x16x32_bf16 v[8:11], v[36:39], v[68:71], v[8:11]
  ds_read_b64_tr_b16 v[36:37], v5 offset:0
  ds_read_b64_tr_b16 v[38:39], v5 offset:512
  s_waitcnt lgkmcnt(10)
  v_mfma_f32_16x16x32_bf16 v[8:11], v[40:43], v[72:75], v[8:11]
  ds_read_b64_tr_b16 v[40:41], v5 offset:4096
  ds_read_b64_tr_b16 v[42:43], v5 offset:4608
  s_waitcnt lgkmcnt(10)
  v_mfma_f32_16x16x32_bf16 v[8:11], v[44:47], v[76:79], v[8:11]
  ds_read_b64_tr_b16 v[44:45], v5 offset:8192
  ds_read_b64_tr_b16 v[46:47], v5 offset:8704
  s_waitcnt lgkmcnt(10)
  v_mfma_f32_16x16x32_bf16 v[8:11], v[24:27], v[80:83], v[8:11]
  ds_read_b64_tr_b16 v[24:25], v5 offset:12288
  ds_read_b64_tr_b16 v[26:27], v5 offset:12800
  s_waitcnt lgkmcnt(10)
  v_mfma_f32_16x16x32_bf16 v[8:11], v[28:31], v[84:87], v[8:11]
  ds_read_b64_tr_b16 v[28:29], v5 offset:16384
  ds_read_b64_tr_b16 v[30:31], v5 offset:16896
  s_waitcnt lgkmcnt(10)
  v_mfma_f32_16x16x32_bf16 v[8:11], v[32:35], v[88:91], v[8:11]
  ds_read_b64_tr_b16 v[32:33], v5 offset:20480
  ds_read_b64_tr_b16 v[34:35], v5 offset:20992
  s_waitcnt lgkmcnt(10)
  v_mfma_f32_16x16x32_bf16 v[8:11], v[36:39], v[92:95], v[8:11]
  ds_read_b64_tr_b16 v[36:37], v5 offset:24576
  ds_read_b64_tr_b16 v[38:39], v5 offset:25088
  s_waitcnt lgkmcnt(10)
  v_mfma_f32_16x16x32_bf16 v[8:11], v[40:43], v[96:99], v[8:11]
  ds_read_b64_tr_b16 v[40:41], v5 offset:28672
  ds_read_b64_tr_b16 v[42:43], v5 offset:29184
  s_waitcnt lgkmcnt(10)
  v_mfma_f32_16x16x32_bf16 v[8:11], v[44:47], v[100:103], v[8:11]
  ds_read_b64_tr_b16 v[44:45], v5 offset:32768
  ds_read_b64_tr_b16 v[46:47], v5 offset:33280
  s_waitcnt lgkmcnt(10)
  v_mfma_f32_16x16x32_bf16 v[8:11], v[24:27], v[104:107], v[8:11]
  s_waitcnt lgkmcnt(8)
  v_mfma_f32_16x16x32_bf16 v[8:11], v[28:31], v[108:111], v[8:11]
  s_waitcnt lgkmcnt(6)
  v_mfma_f32_16x16x32_bf16 v[8:11], v[32:35], v[112:115], v[8:11]
  s_waitcnt lgkmcnt(4)
  v_mfma_f32_16x16x32_bf16 v[8:11], v[36:39], v[116:119], v[8:11]
  s_waitcnt lgkmcnt(2)
  v_mfma_f32_16x16x32_bf16 v[8:11], v[40:43], v[120:123], v[8:11]
  s_waitcnt lgkmcnt(0)
  v_mfma_f32_16x16x32_bf16 v[8:11], v[44:47], v[124:127], v[8:11]
  s_barrier
  s_nop 7
  v_cvt_pk_bf16_f32 v16, v8, v9
  v_cvt_pk_bf16_f32 v18, v10, v11
  v_and_b32 v17, 0xffff0000, v16
  v_lshlrev_b32 v16, 16, v16
  v_and_b32 v19, 0xffff0000, v18
  v_lshlrev_b32 v18, 16, v18
  s_barrier
  ds_read_b64_tr_b16 v[24:25], v2 offset:0
  ds_read_b64_tr_b16 v[26:27], v2 offset:512
  ds_read_b64_tr_b16 v[28:29], v2 offset:4096
  ds_read_b64_tr_b16 v[30:31], v2 offset:4608
  ds_read_b64_tr_b16 v[32:33], v2 offset:8192
  ds_read_b64_tr_b16 v[34:35], v2 offset:8704
  ds_read_b64_tr_b16 v[36:37], v2 offset:12288
  ds_read_b64_tr_b16 v[38:39], v2 offset:12800
  ds_read_b64_tr_b16 v[40:41], v2 offset:16384
  ds_read_b64_tr_b16 v[42:43], v2 offset:16896
  ds_read_b64_tr_b16 v[44:45], v2 offset:20480
  ds_read_b64_tr_b16 v[46:47], v2 offset:20992
  s_waitcnt lgkmcnt(10)
  v_mfma_f32_16x16x32_bf16 v[8:11], v[24:27], v[56:59], 0
  ds_read_b64_tr_b16 v[24:25], v2 offset:24576
  ds_read_b64_tr_b16 v[26:27], v2 offset:25088
  s_waitcnt lgkmcnt(10)
  v_mfma_f32_16x16x32_bf16 v[8:11], v[28:31], v[60:63], v[8:11]
  ds_read_b64_tr_b16 v[28:29], v2 offset:28672
  ds_read_b64_tr_b16 v[30:31], v2 offset:29184
  s_waitcnt lgkmcnt(10)
  v_mfma_f32_16x16x32_bf16 v[8:11], v[32:35], v[64:67], v[8:11]
  ds_read_b64_tr_b16 v[32:33], v2 offset:32768
  ds_read_b64_tr_b16 v[34:35], v2 offset:33280
  s_waitcnt lgkmcnt(10)
  v_mfma_f32_16x16x32_bf16 v[8:11], v[36:39], v[68:71], v[8:11]
  ds_read_b64_tr_b16 v[36:37], v3 offset:0
  ds_read_b64_tr_b16 v[38:39], v3 offset:512
  s_waitcnt lgkmcnt(10)
  v_mfma_f32_16x16x32_bf16 v[8:11], v[40:43], v[72:75], v[8:11]
  ds_read_b64_tr_b16 v[40:41], v3 offset:4096
  ds_read_b64_tr_b16 v[42:43], v3 offset:4608
  s_waitcnt lgkmcnt(10)
  v_mfma_f32_16x16x32_bf16 v[8:11], v[44:47], v[76:79], v[8:11]
  ds_read_b64_tr_b16 v[44:45], v3 offset:8192
  ds_read_b64_tr_b16 v[46:47], v3 offset:8704
  s_waitcnt lgkmcnt(10)
  v_mfma_f32_16x16x32_bf16 v[8:11], v[24:27], v[80:83], v[8:11]
  ds_read_b64_tr_b16 v[24:25], v3 offset:12288
  ds_read_b64_tr_b16 v[26:27], v3 offset:12800
  s_waitcnt lgkmcnt(10)
  v_mfma_f32_16x16x32_bf16 v[8:11], v[28:31], v[84:87], v[8:11]
  ds_read_b64_tr_b16 v[28:29], v3 offset:16384
  ds_read_b64_tr_b16 v[30:31], v3 offset:16896
  s_waitcnt lgkmcnt(10)
  v_mfma_f32_16x16x32_bf16 v[8:11], v[32:35], v[88:91], v[8:11]
  ds_read_b64_tr_b16 v[32:33], v3 offset:20480
  ds_read_b64_tr_b16 v[34:35], v3 offset:20992
  s_waitcnt lgkmcnt(10)
  v_mfma_f32_16x16x32_bf16 v[8:11], v[36:39], v[92:95], v[8:11]
  ds_read_b64_tr_b16 v[36:37], v3 offset:24576
  ds_read_b64_tr_b16 v[38:39], v3 offset:25088
  s_waitcnt lgkmcnt(10)
  v_mfma_f32_16x16x32_bf16 v[8:11], v[40:43], v[96:99], v[8:11]
  ds_read_b64_tr_b16 v[40:41], v3 offset:28672
  ds_read_b64_tr_b16 v[42:43], v3 offset:29184
  s_waitcnt lgkmcnt(10)
  v_mfma_f32_16x16x32_bf16 v[8:11], v[44:47], v[100:103], v[8:11]
  ds_read_b64_tr_b16 v[44:45], v3 offset:32768
  ds_read_b64_tr_b16 v[46:47], v3 offset:33280
  s_waitcnt lgkmcnt(10)
  v_mfma_f32_16x16x32_bf16 v[8:11], v[24:27], v[104:107], v[8:11]
  s_waitcnt lgkmcnt(8)
  v_mfma_f32_16x16x32_bf16 v[8:11], v[28:31], v[108:111], v[8:11]
  s_waitcnt lgkmcnt(6)
  v_mfma_f32_16x16x32_bf16 v[8:11], v[32:35], v[112:115], v[8:11]
  s_waitcnt lgkmcnt(4)
  v_mfma_f32_16x16x32_bf16 v[8:11], v[36:39], v[116:119], v[8:11]
  s_waitcnt lgkmcnt(2)
  v_mfma_f32_16x16x32_bf16 v[8:11], v[40:43], v[120:123], v[8:11]
  s_waitcnt lgkmcnt(0)
  v_mfma_f32_16x16x32_bf16 v[8:11], v[44:47], v[124:127], v[8:11]
  s_nop 7
  v_cvt_pk_bf16_f32 v12, v8, v9
  v_lshlrev_b32 v8, 16, v12
  v_and_b32 v9, 0xffff0000, v12
  v_cvt_pk_bf16_f32 v12, v10, v11
  v_lshlrev_b32 v10, 16, v12
  v_and_b32 v11, 0xffff0000, v12
  v_mul_f32 v8, v8, v16
  v_mul_f32 v9, v9, v17
  v_mul_f32 v10, v10, v18
  v_mul_f32 v11, v11, v19
  v_cvt_pk_bf16_f32 v12, v8, v9
  v_cvt_pk_bf16_f32 v13, v10, v11
  v_min_u32 v12, -2, v12
  v_min_u32 v13, -2, v13
  s_mov_b32 exec_lo, 0x00ff00ff
  s_mov_b32 exec_hi, 0x00ff00ff
  ds_write_b64 v6, v[12:13]
  s_mov_b64 exec, -1
  s_waitcnt lgkmcnt(0)
  s_barrier
  s_cmp_lg_u32 s3, 0
  s_cbranch_scc1 L_pb_h
  ds_read_b128 v[12:15], v7
  v_lshlrev_b32 v21, 4, v0
  s_waitcnt lgkmcnt(0)
  buffer_store_dwordx4 v[12:15], v21, s[48:51], s43 offen sc1
L_pb_h:
  s_barrier
  v_and_b32 v6, 7, v0
  v_lshlrev_b32 v6, 7, v6
  v_bfe_u32 v16, v0, 3, 1
  v_lshl_add_u32 v6, v16, 6, v6
  v_lshrrev_b32 v16, 4, v0
  v_lshl_add_u32 v6, v16, 4, v6
  v_and_b32 v7, 7, v0
  v_lshrrev_b32 v16, 4, v0
  v_lshl_add_u32 v7, v16, 3, v7
  v_lshlrev_b32 v7, 4, v7
  s_load_dword s64, s[24:25], 192
  s_waitcnt lgkmcnt(0)
  s_cmp_lg_u32 s64, 0
  s_cbranch_scc1 L_drd_f
  v_mov_b32 v22, 0
L_dr_f:
  global_load_dword v23, v22, s[24:25] offset:192 sc1
  s_waitcnt vmcnt(0)
  v_readfirstlane_b32 s64, v23
  s_cmp_lg_u32 s64, 0
  s_cbranch_scc1 L_drd_f
  s_sleep 16
  s_add_u32 s62, s62, 1
  s_cmp_lt_u32 s62, 0x40000
  s_cbranch_scc1 L_dr_f
L_drd_f:
  s_lshr_b32 s63, s64, 2
  s_and_b32 s64, s64, 1
  s_lshl_b32 s42, s52, 2
  s_add_u32 s42, s42, s3
  s_mul_hi_u32 s31, s42, 0x1c71c71d
  s_mul_i32 s30, s31, 9
  s_sub_u32 s30, s42, s30
  s_lshl_b32 s31, s31, 1
  s_cmp_ge_u32 s30, 5
  s_cselect_b32 s68, 5, 0
  s_cselect_b32 s69, 5, 4
  s_addc_u32 s31, s31, 0
  s_sub_u32 s30, s30, s68
  s_add_u32 s31, s31, s63
  s_and_b32 s31, s31, 7
  s_bitcmp1_b32 s31, 0
  s_cselect_b32 s69, s69, 0
  s_add_u32 s30, s30, s69
  s_bitcmp1_b32 s31, 1
  s_cselect_b32 s69, 9, 0
  s_add_u32 s30, s30, s69
  s_lshr_b32 s31, s31, 2
  s_lshr_b32 s68, s30, 1
  s_lshl_b32 s68, s68, 2
  s_and_b32 s69, s30, 1
  s_or_b32 s68, s68, s69
  s_xor_b32 s69, s31, s64
  s_lshl_b32 s69, s69, 1
  s_or_b32 s43, s68, s69
  v_add_u32 v6, 147456, v6
  s_lshl_b32 s30, s43, 12
  s_lshl_b32 s31, s28, 9
  s_add_u32 s30, s30, s31
  s_add_u32 s30, s30, 278528
  s_bfe_u32 s68, s30, 0x4000c
  s_lshl_b32 s68, s68, 23
  s_or_b32 s30, s30, s68
  v_add_u32 v7, s30, v7
  s_barrier
  ds_read_b64_tr_b16 v[56:57], v4 offset:0
  ds_read_b64_tr_b16 v[58:59], v4 offset:512
  ds_read_b64_tr_b16 v[60:61], v4 offset:4096
  ds_read_b64_tr_b16 v[62:63], v4 offset:4608
  ds_read_b64_tr_b16 v[64:65], v4 offset:8192
  ds_read_b64_tr_b16 v[66:67], v4 offset:8704
  ds_read_b64_tr_b16 v[68:69], v4 offset:12288
  ds_read_b64_tr_b16 v[70:71], v4 offset:12800
  s_waitcnt lgkmcnt(7)
  ds_read_b64_tr_b16 v[72:73], v4 offset:16384
  ds_read_b64_tr_b16 v[74:75], v4 offset:16896
  ds_read_b64_tr_b16 v[76:77], v4 offset:20480
  ds_read_b64_tr_b16 v[78:79], v4 offset:20992
  ds_read_b64_tr_b16 v[80:81], v4 offset:24576
  ds_read_b64_tr_b16 v[82:83], v4 offset:25088
  ds_read_b64_tr_b16 v[84:85], v4 offset:28672
  ds_read_b64_tr_b16 v[86:87], v4 offset:29184
  s_waitcnt lgkmcnt(7)
  ds_read_b64_tr_b16 v[88:89], v4 offset:32768
  ds_read_b64_tr_b16 v[90:91], v4 offset:33280
  ds_read_b64_tr_b16 v[92:93], v5 offset:0
  ds_read_b64_tr_b16 v[94:95], v5 offset:512
  ds_read_b64_tr_b16 v[96:97], v5 offset:4096
  ds_read_b64_tr_b16 v[98:99], v5 offset:4608
  ds_read_b64_tr_b16 v[100:101], v5 offset:8192
  ds_read_b64_tr_b16 v[102:103], v5 offset:8704
  s_waitcnt lgkmcnt(7)
  ds_read_b64_tr_b16 v[104:105], v5 offset:12288
  ds_read_b64_tr_b16 v[106:107], v5 offset:12800
  ds_read_b64_tr_b16 v[108:109], v5 offset:16384
  ds_read_b64_tr_b16 v[110:111], v5 offset:16896
  ds_read_b64_tr_b16 v[112:113], v5 offset:20480
  ds_read_b64_tr_b16 v[114:115], v5 offset:20992
  ds_read_b64_tr_b16 v[116:117], v5 offset:24576
  ds_read_b64_tr_b16 v[118:119], v5 offset:25088
  s_waitcnt lgkmcnt(7)
  s_waitcnt lgkmcnt(0)
  s_barrier
  ds_read_b128 v[24:27], v6 offset:0
  ds_read_b128 v[28:31], v6 offset:1024
  ds_read_b128 v[32:35], v6 offset:2048
  ds_read_b128 v[36:39], v6 offset:3072
  ds_read_b128 v[40:43], v6 offset:4096
  ds_read_b128 v[44:47], v6 offset:5120
  ds_read_b128 v[48:51], v6 offset:6144
  ds_read_b128 v[52:55], v6 offset:7168
  s_waitcnt lgkmcnt(7)
  v_mfma_f32_16x16x32_bf16 v[8:11], v[56:59], v[24:27], 0
  v_mfma_f32_16x16x32_bf16 v[12:15], v[60:63], v[24:27], 0
  s_waitcnt lgkmcnt(6)
  v_mfma_f32_16x16x32_bf16 v[8:11], v[64:67], v[28:31], v[8:11]
  v_mfma_f32_16x16x32_bf16 v[12:15], v[68:71], v[28:31], v[12:15]
  s_waitcnt lgkmcnt(5)
  v_mfma_f32_16x16x32_bf16 v[8:11], v[72:75], v[32:35], v[8:11]
  v_mfma_f32_16x16x32_bf16 v[12:15], v[76:79], v[32:35], v[12:15]
  s_waitcnt lgkmcnt(4)
  v_mfma_f32_16x16x32_bf16 v[8:11], v[80:83], v[36:39], v[8:11]
  v_mfma_f32_16x16x32_bf16 v[12:15], v[84:87], v[36:39], v[12:15]
  s_waitcnt lgkmcnt(3)
  v_mfma_f32_16x16x32_bf16 v[8:11], v[88:91], v[40:43], v[8:11]
  v_mfma_f32_16x16x32_bf16 v[12:15], v[92:95], v[40:43], v[12:15]
  s_waitcnt lgkmcnt(2)
  v_mfma_f32_16x16x32_bf16 v[8:11], v[96:99], v[44:47], v[8:11]
  v_mfma_f32_16x16x32_bf16 v[12:15], v[100:103], v[44:47], v[12:15]
  s_waitcnt lgkmcnt(1)
  v_mfma_f32_16x16x32_bf16 v[8:11], v[104:107], v[48:51], v[8:11]
  v_mfma_f32_16x16x32_bf16 v[12:15], v[108:111], v[48:51], v[12:15]
  s_waitcnt lgkmcnt(0)
  v_mfma_f32_16x16x32_bf16 v[8:11], v[112:115], v[52:55], v[8:11]
  v_mfma_f32_16x16x32_bf16 v[12:15], v[116:119], v[52:55], v[12:15]
  s_nop 7
  v_add_f32_dpp v8, v12, v8 row_ror:8 row_mask:0xf bank_mask:0xf
  v_add_f32_dpp v9, v13, v9 row_ror:8 row_mask:0xf bank_mask:0xf
  v_add_f32_dpp v10, v14, v10 row_ror:8 row_mask:0xf bank_mask:0xf
  v_add_f32_dpp v11, v15, v11 row_ror:8 row_mask:0xf bank_mask:0xf
  v_min_u32 v8, -2, v8
  v_min_u32 v9, -2, v9
  v_min_u32 v10, -2, v10
  v_min_u32 v11, -2, v11
  s_mov_b32 exec_lo, 0x00ff00ff
  s_mov_b32 exec_hi, 0x00ff00ff
  buffer_store_dwordx4 v[8:11], v7, s[48:51], 0 offen sc1
  s_endpgm
L_X:
  s_mul_i32 s52, s53, 9
  s_add_u32 s52, s52, s57
  s_lshl_b32 s30, s63, 4
  s_add_u32 s30, s30, s3
  s_lshl_b32 s58, s30, 10
  s_add_u32 s59, s58, 212992
  v_lshlrev_b32 v2, 4, v0
  v_mov_b32 v4, -1
  v_mov_b32 v5, -1
  v_mov_b32 v6, -1
  v_mov_b32 v7, -1
  v_lshlrev_b32 v8, 6, v0
  v_mov_b32 v9, 1
  s_bfe_u32 s68, s58, 0x4000c
  s_lshl_b32 s68, s68, 23
  s_or_b32 s58, s58, s68
  s_bfe_u32 s68, s59, 0x4000c
  s_lshl_b32 s68, s68, 23
  s_or_b32 s59, s59, s68
  s_waitcnt lgkmcnt(0)
  s_mov_b32 s48, s26
  s_mov_b32 s49, s27
  s_mov_b32 s50, 268435456
  s_mov_b32 s51, 0x20000
  s_cmp_ge_u32 s63, 13
  s_cbranch_scc1 L_X_noat
  buffer_store_dwordx4 v[4:7], v2, s[48:51], s58 offen sc1
  buffer_store_dwordx4 v[4:7], v2, s[48:51], s59 offen sc1
  s_waitcnt vmcnt(0)
  s_barrier
  s_cmp_lg_u32 s3, 8
  s_cbranch_scc1 L_X_noat
  s_mov_b64 exec, 7
  global_atomic_add v8, v9, s[24:25] sc1
  s_mov_b64 exec, -1
L_X_noat:
  v_lshrrev_b32 v1, 3, v0
  v_bfe_u32 v3, v1, 1, 1
  s_and_b32 s30, s3, 1
  s_lshl_b32 s30, s30, 2
  v_mul_u32_u24 v3, 3, v3
  v_add_u32 v3, s30, v3
  v_and_b32 v2, 7, v0
  v_xor_b32 v2, v2, v3
  v_lshlrev_b32 v2, 4, v2
  s_lshl_b32 s30, s3, 3
  v_add_u32 v1, s30, v1
  v_mul_u32_u24 v4, 1152, v1
  v_add_u32 v4, v4, v2
  s_lshl_b32 s58, s3, 10
  s_mul_i32 s59, s53, 1327104
  s_lshl_b32 s30, s57, 7
  s_add_u32 s59, s59, s30
  s_sub_u32 s60, 5308416, s59
  s_add_u32 s32, s20, s59
  s_addc_u32 s33, s21, 0
  s_mov_b32 s34, s60
  s_mov_b32 s35, 0x20000
  s_cmp_lg_u32 s63, 0
  s_cbranch_scc1 L_X_nomeas
  s_cmp_lg_u32 s3, 15
  s_cbranch_scc1 L_X_nomeas
  v_lshlrev_b32 v10, 13, v0
  v_add_u32 v10, 425984, v10
  s_add_u32 s40, s26, 425984
  s_addc_u32 s41, s27, 0
  s_mov_b64 exec, 3
  buffer_store_dword v9, v10, s[48:51], 0 offen sc1
  s_mov_b64 exec, -1
  s_mov_b32 s44, 0
  s_waitcnt vmcnt(0)
  s_mov_b32 s42, 0
  s_mov_b32 s43, 0
  s_load_dword s42, s[40:41], 0 glc
  s_load_dword s43, s[40:41], 8192 glc
  s_waitcnt lgkmcnt(1)
  s_sub_u32 s45, s43, s42
  s_waitcnt lgkmcnt(0)
  s_add_u32 s44, s44, s45
  s_mov_b32 s42, 0
  s_mov_b32 s43, 0
  s_load_dword s43, s[40:41], 8192 glc
  s_load_dword s42, s[40:41], 0 glc
  s_waitcnt lgkmcnt(1)
  s_sub_u32 s45, s43, s42
  s_waitcnt lgkmcnt(0)
  s_add_u32 s44, s44, s45
  s_mov_b32 s42, 0
  s_mov_b32 s43, 0
  s_load_dword s42, s[40:41], 0 glc
  s_load_dword s43, s[40:41], 8192 glc
  s_waitcnt lgkmcnt(1)
  s_sub_u32 s45, s43, s42
  s_waitcnt lgkmcnt(0)
  s_add_u32 s44, s44, s45
  s_mov_b32 s42, 0
  s_mov_b32 s43, 0
  s_load_dword s43, s[40:41], 8192 glc
  s_load_dword s42, s[40:41], 0 glc
  s_waitcnt lgkmcnt(1)
  s_sub_u32 s45, s43, s42
  s_waitcnt lgkmcnt(0)
  s_add_u32 s44, s44, s45
  s_mov_b32 s42, 0
  s_mov_b32 s43, 0
  s_load_dword s42, s[40:41], 0 glc
  s_load_dword s43, s[40:41], 8192 glc
  s_waitcnt lgkmcnt(1)
  s_sub_u32 s45, s43, s42
  s_waitcnt lgkmcnt(0)
  s_add_u32 s44, s44, s45
  s_mov_b32 s42, 0
  s_mov_b32 s43, 0
  s_load_dword s43, s[40:41], 8192 glc
  s_load_dword s42, s[40:41], 0 glc
  s_waitcnt lgkmcnt(1)
  s_sub_u32 s45, s43, s42
  s_waitcnt lgkmcnt(0)
  s_add_u32 s44, s44, s45
  s_cmp_gt_i32 s44, 0
  s_cselect_b32 s45, 3, 2
  s_getreg_b32 s46, hwreg(HW_REG_XCC_ID, 0, 3)
  s_lshr_b32 s47, s46, 2
  s_xor_b32 s45, s45, s47
  s_lshl_b32 s46, s46, 2
  s_or_b32 s45, s45, s46
  v_mov_b32 v10, 0
  v_mov_b32 v11, s45
  s_mov_b64 exec, 1
  global_store_dword v10, v11, s[24:25] offset:192 sc1
  s_mov_b64 exec, -1
L_X_nomeas:
  s_cmp_lg_u32 s3, 12
  s_cbranch_scc1 L_X_go
  s_sleep 72
  s_load_dword s30, s[24:25], 0
  s_waitcnt lgkmcnt(0)
  s_cmp_ge_u32 s30, 13
  s_cbranch_scc1 L_ccd_x
  s_sleep 20
  s_load_dword s30, s[24:25], 64
  s_waitcnt lgkmcnt(0)
  s_cmp_ge_u32 s30, 13
  s_cbranch_scc1 L_ccd_x
  s_sleep 20
  s_load_dword s30, s[24:25], 128
  s_waitcnt lgkmcnt(0)
  s_cmp_ge_u32 s30, 13
  s_cbranch_scc1 L_ccd_x
  s_sleep 20
  v_mov_b32 v12, 0
L_cc_x:
  global_load_dword v13, v12, s[24:25] sc1
  s_waitcnt vmcnt(0)
  v_readfirstlane_b32 s30, v13
  s_cmp_ge_u32 s30, 13
  s_cbranch_scc1 L_ccd_x
  s_sleep 16
  s_add_u32 s62, s62, 1
  s_cmp_lt_u32 s62, 0x40000
  s_cbranch_scc1 L_cc_x
L_ccd_x:
  s_lshl_b32 s61, s28, 13
  s_add_u32 s61, s61, 0
  s_bfe_u32 s68, s61, 0x4000c
  s_lshl_b32 s68, s68, 23
  s_or_b32 s61, s61, s68
  v_mov_b32 v12, 0
  s_mov_b64 exec, 1
L_X_qw:
  buffer_load_dword v13, v12, s[48:51], s61 offen sc1
  s_waitcnt vmcnt(0)
  v_cmp_eq_u32 vcc, -1, v13
  s_cbranch_vccz L_X_qd
  s_sleep 12
  s_add_u32 s62, s62, 1
  s_cmp_lt_u32 s62, 0x40000
  s_cbranch_scc1 L_X_qw
L_X_qd:
  s_mov_b64 exec, -1
L_X_go:
  s_barrier
  s_waitcnt vmcnt(0)
  s_add_u32 m0, s58, 0
  s_mov_b32 s31, 0
  buffer_load_dwordx4 v4, s[32:35], s31 offen nt lds
  s_waitcnt vmcnt(0)
  s_add_u32 m0, s58, 16384
  s_mov_b32 s31, 147456
  buffer_load_dwordx4 v4, s[32:35], s31 offen nt lds
  s_waitcnt vmcnt(0)
  s_add_u32 m0, s58, 32768
  s_mov_b32 s31, 294912
  buffer_load_dwordx4 v4, s[32:35], s31 offen nt lds
  s_waitcnt vmcnt(0)
  s_add_u32 m0, s58, 49152
  s_mov_b32 s31, 442368
  buffer_load_dwordx4 v4, s[32:35], s31 offen nt lds
  s_waitcnt vmcnt(0)
  s_add_u32 m0, s58, 65536
  s_mov_b32 s31, 589824
  buffer_load_dwordx4 v4, s[32:35], s31 offen nt lds
  s_waitcnt vmcnt(0)
  s_add_u32 m0, s58, 81920
  s_mov_b32 s31, 737280
  buffer_load_dwordx4 v4, s[32:35], s31 offen nt lds
  s_waitcnt vmcnt(0)
  s_add_u32 m0, s58, 98304
  s_mov_b32 s31, 884736
  buffer_load_dwordx4 v4, s[32:35], s31 offen nt lds
  s_waitcnt vmcnt(0)
  s_add_u32 m0, s58, 114688
  s_mov_b32 s31, 1032192
  buffer_load_dwordx4 v4, s[32:35], s31 offen nt lds
  s_waitcnt vmcnt(0)
  s_add_u32 m0, s58, 131072
  s_mov_b32 s31, 1179648
  buffer_load_dwordx4 v4, s[32:35], s31 offen nt lds
L_X_nocc:
  s_waitcnt vmcnt(0)
  s_barrier
  s_cmp_gt_u32 s3, 12
  s_cbranch_scc1 L_end
  s_cmp_eq_u32 s3, 12
  s_cbranch_scc1 L_R
  s_mul_i32 s30, s53, 18432
  s_add_u32 s60, s30, 65536
  s_cmp_lt_u32 s3, 4
  s_cbranch_scc1 L_D
  s_sub_u32 s31, s3, 4
  s_lshl_b32 s31, s31, 11
  s_add_u32 s60, s60, s31
  s_bfe_u32 s68, s60, 0x4000c
  s_lshl_b32 s68, s68, 23
  s_or_b32 s60, s60, s68
  v_lshlrev_b32 v16, 4, v0
  s_add_u32 s31, s31, 147456
  v_add_u32 v17, s31, v16
  v_lshlrev_b32 v18, 10, v0
  s_mov_b64 exec, 3
L_hp_x:
  buffer_load_dword v19, v18, s[48:51], s60 offen offset:96 sc1
  s_waitcnt vmcnt(0)
  v_cmp_eq_u32 vcc, -1, v19
  s_cbranch_vccz L_hpd_x
  s_mov_b64 exec, vcc
  s_sleep 8
  s_add_u32 s62, s62, 1
  s_cmp_lt_u32 s62, 0x40000
  s_cbranch_scc1 L_hp_x
L_hpd_x:
  s_mov_b64 exec, -1
L_hg_x:
  buffer_load_dwordx4 v[20:23], v16, s[48:51], s60 offen sc1
  buffer_load_dwordx4 v[24:27], v16, s[48:51], s60 offen offset:1024 sc1
  s_waitcnt vmcnt(0)
  v_max3_u32 v18, v20, v21, v22
  v_max3_u32 v18, v18, v23, v24
  v_max3_u32 v18, v18, v25, v26
  v_max_u32 v18, v18, v27
  v_cmp_eq_u32 vcc, -1, v18
  s_cbranch_vccz L_hgd_x
  s_sleep 2
  s_add_u32 s62, s62, 1
  s_cmp_lt_u32 s62, 0x40000
  s_cbranch_scc1 L_hg_x
L_hgd_x:
  ds_write_b128 v17, v[20:23]
  ds_write_b128 v17, v[24:27] offset:1024
  s_waitcnt lgkmcnt(0)
  s_barrier
  s_endpgm
L_D:
  s_add_u32 s60, s60, 16384
  s_bfe_u32 s68, s60, 0x4000c
  s_lshl_b32 s68, s68, 23
  s_or_b32 s60, s60, s68
  v_and_b32 v6, 7, v0
  v_lshlrev_b32 v6, 7, v6
  v_bfe_u32 v16, v0, 3, 1
  v_lshl_add_u32 v6, v16, 6, v6
  v_lshrrev_b32 v16, 4, v0
  v_lshl_add_u32 v6, v16, 4, v6
  v_lshrrev_b32 v3, 4, v0
  v_bfe_u32 v4, v0, 2, 2
  v_lshl_add_u32 v2, v3, 3, v4
  v_lshlrev_b32 v2, 7, v2
  v_and_b32 v3, 1, v3
  v_lshlrev_b32 v3, 2, v3
  v_lshrrev_b32 v4, 1, v4
  v_mad_u32_u24 v3, v4, 3, v3
  v_bfe_u32 v4, v0, 1, 1
  s_lshl_b32 s30, s3, 1
  v_add_u32 v4, s30, v4
  v_xor_b32 v3, v3, v4
  v_lshl_add_u32 v2, v3, 4, v2
  v_and_b32 v3, 1, v0
  v_lshl_add_u32 v2, v3, 3, v2
  v_add_u32 v3, 36864, v2
  v_add_u32 v4, 73728, v2
  v_add_u32 v5, 110592, v2
  v_and_b32 v7, 7, v0
  v_lshrrev_b32 v16, 4, v0
  v_lshl_add_u32 v7, v16, 3, v7
  v_lshlrev_b32 v7, 4, v7
  s_lshl_b32 s30, s57, 2
  s_add_u32 s30, s30, s3
  s_lshl_b32 s30, s30, 11
  s_lshl_b32 s31, s53, 9
  s_add_u32 s30, s30, s31
  s_add_u32 s30, s30, 139264
  s_bfe_u32 s68, s30, 0x4000c
  s_lshl_b32 s68, s68, 23
  s_or_b32 s30, s30, s68
  v_add_u32 v7, s30, v7
  v_lshlrev_b32 v18, 10, v0
  s_mov_b64 exec, 3
L_hp_d:
  buffer_load_dword v19, v18, s[48:51], s60 offen offset:96 sc1
  s_waitcnt vmcnt(0)
  v_cmp_eq_u32 vcc, -1, v19
  s_cbranch_vccz L_hpd_d
  s_mov_b64 exec, vcc
  s_sleep 8
  s_add_u32 s62, s62, 1
  s_cmp_lt_u32 s62, 0x40000
  s_cbranch_scc1 L_hp_d
L_hpd_d:
  s_mov_b64 exec, -1
L_hg_d:
  buffer_load_dwordx4 v[120:123], v6, s[48:51], s60 offen sc1
  buffer_load_dwordx4 v[124:127], v6, s[48:51], s60 offen offset:1024 sc1
  s_waitcnt vmcnt(0)
  v_max3_u32 v18, v120, v121, v122
  v_max3_u32 v18, v18, v123, v124
  v_max3_u32 v18, v18, v125, v126
  v_max_u32 v18, v18, v127
  v_cmp_eq_u32 vcc, -1, v18
  s_cbranch_vccz L_hgd_d
  s_sleep 2
  s_add_u32 s62, s62, 1
  s_cmp_lt_u32 s62, 0x40000
  s_cbranch_scc1 L_hg_d
L_hgd_d:
  v_add_u32 v6, 147456, v6
  ds_read_b64_tr_b16 v[24:25], v2 offset:0
  ds_read_b64_tr_b16 v[26:27], v2 offset:512
  ds_read_b64_tr_b16 v[28:29], v2 offset:4096
  ds_read_b64_tr_b16 v[30:31], v2 offset:4608
  ds_read_b64_tr_b16 v[32:33], v2 offset:8192
  ds_read_b64_tr_b16 v[34:35], v2 offset:8704
  ds_read_b64_tr_b16 v[36:37], v2 offset:12288
  ds_read_b64_tr_b16 v[38:39], v2 offset:12800
  s_barrier
  ds_read_b128 v[56:59], v6 offset:0
  ds_read_b128 v[60:63], v6 offset:1024
  s_waitcnt lgkmcnt(1)
  v_mfma_f32_16x16x32_bf16 v[8:11], v[24:27], v[56:59], 0
  ds_read_b128 v[64:67], v6 offset:2048
  ds_read_b64_tr_b16 v[40:41], v2 offset:16384
  ds_read_b64_tr_b16 v[42:43], v2 offset:16896
  v_mfma_f32_16x16x32_bf16 v[12:15], v[28:31], v[56:59], 0
  ds_read_b64_tr_b16 v[44:45], v2 offset:20480
  ds_read_b64_tr_b16 v[46:47], v2 offset:20992
  s_waitcnt lgkmcnt(5)
  v_mfma_f32_16x16x32_bf16 v[8:11], v[32:35], v[60:63], v[8:11]
  ds_read_b128 v[68:71], v6 offset:3072
  ds_read_b64_tr_b16 v[48:49], v2 offset:24576
  ds_read_b64_tr_b16 v[50:51], v2 offset:25088
  v_mfma_f32_16x16x32_bf16 v[12:15], v[36:39], v[60:63], v[12:15]
  ds_read_b64_tr_b16 v[52:53], v2 offset:28672
  ds_read_b64_tr_b16 v[54:55], v2 offset:29184
  s_waitcnt lgkmcnt(7)
  v_mfma_f32_16x16x32_bf16 v[8:11], v[40:43], v[64:67], v[8:11]
  ds_read_b128 v[72:75], v6 offset:4096
  ds_read_b64_tr_b16 v[24:25], v2 offset:32768
  ds_read_b64_tr_b16 v[26:27], v2 offset:33280
  s_waitcnt lgkmcnt(8)
  v_mfma_f32_16x16x32_bf16 v[12:15], v[44:47], v[64:67], v[12:15]
  ds_read_b64_tr_b16 v[28:29], v3 offset:0
  ds_read_b64_tr_b16 v[30:31], v3 offset:512
  s_waitcnt lgkmcnt(7)
  v_mfma_f32_16x16x32_bf16 v[8:11], v[48:51], v[68:71], v[8:11]
  ds_read_b128 v[76:79], v6 offset:5120
  ds_read_b64_tr_b16 v[32:33], v3 offset:4096
  ds_read_b64_tr_b16 v[34:35], v3 offset:4608
  s_waitcnt lgkmcnt(8)
  v_mfma_f32_16x16x32_bf16 v[12:15], v[52:55], v[68:71], v[12:15]
  ds_read_b64_tr_b16 v[36:37], v3 offset:8192
  ds_read_b64_tr_b16 v[38:39], v3 offset:8704
  s_waitcnt lgkmcnt(7)
  v_mfma_f32_16x16x32_bf16 v[8:11], v[24:27], v[72:75], v[8:11]
  ds_read_b128 v[80:83], v6 offset:6144
  ds_read_b64_tr_b16 v[40:41], v3 offset:12288
  ds_read_b64_tr_b16 v[42:43], v3 offset:12800
  s_waitcnt lgkmcnt(8)
  v_mfma_f32_16x16x32_bf16 v[12:15], v[28:31], v[72:75], v[12:15]
  ds_read_b64_tr_b16 v[44:45], v3 offset:16384
  ds_read_b64_tr_b16 v[46:47], v3 offset:16896
  s_waitcnt lgkmcnt(7)
  v_mfma_f32_16x16x32_bf16 v[8:11], v[32:35], v[76:79], v[8:11]
  ds_read_b128 v[84:87], v6 offset:7168
  ds_read_b64_tr_b16 v[48:49], v3 offset:20480
  ds_read_b64_tr_b16 v[50:51], v3 offset:20992
  s_waitcnt lgkmcnt(8)
  v_mfma_f32_16x16x32_bf16 v[12:15], v[36:39], v[76:79], v[12:15]
  ds_read_b64_tr_b16 v[52:53], v3 offset:24576
  ds_read_b64_tr_b16 v[54:55], v3 offset:25088
  s_waitcnt lgkmcnt(7)
  v_mfma_f32_16x16x32_bf16 v[8:11], v[40:43], v[80:83], v[8:11]
  ds_read_b128 v[88:91], v6 offset:8192
  ds_read_b64_tr_b16 v[24:25], v3 offset:28672
  ds_read_b64_tr_b16 v[26:27], v3 offset:29184
  s_waitcnt lgkmcnt(8)
  v_mfma_f32_16x16x32_bf16 v[12:15], v[44:47], v[80:83], v[12:15]
  ds_read_b64_tr_b16 v[28:29], v3 offset:32768
  ds_read_b64_tr_b16 v[30:31], v3 offset:33280
  s_waitcnt lgkmcnt(7)
  v_mfma_f32_16x16x32_bf16 v[8:11], v[48:51], v[84:87], v[8:11]
  ds_read_b128 v[92:95], v6 offset:9216
  ds_read_b64_tr_b16 v[32:33], v4 offset:0
  ds_read_b64_tr_b16 v[34:35], v4 offset:512
  s_waitcnt lgkmcnt(8)
  v_mfma_f32_16x16x32_bf16 v[12:15], v[52:55], v[84:87], v[12:15]
  ds_read_b64_tr_b16 v[36:37], v4 offset:4096
  ds_read_b64_tr_b16 v[38:39], v4 offset:4608
  s_waitcnt lgkmcnt(7)
  v_mfma_f32_16x16x32_bf16 v[8:11], v[24:27], v[88:91], v[8:11]
  ds_read_b128 v[96:99], v6 offset:10240
  ds_read_b64_tr_b16 v[40:41], v4 offset:8192
  ds_read_b64_tr_b16 v[42:43], v4 offset:8704
  s_waitcnt lgkmcnt(8)
  v_mfma_f32_16x16x32_bf16 v[12:15], v[28:31], v[88:91], v[12:15]
  ds_read_b64_tr_b16 v[44:45], v4 offset:12288
  ds_read_b64_tr_b16 v[46:47], v4 offset:12800
  s_waitcnt lgkmcnt(7)
  v_mfma_f32_16x16x32_bf16 v[8:11], v[32:35], v[92:95], v[8:11]
  ds_read_b128 v[100:103], v6 offset:11264
  ds_read_b64_tr_b16 v[48:49], v4 offset:16384
  ds_read_b64_tr_b16 v[50:51], v4 offset:16896
  s_waitcnt lgkmcnt(8)
  v_mfma_f32_16x16x32_bf16 v[12:15], v[36:39], v[92:95], v[12:15]
  ds_read_b64_tr_b16 v[52:53], v4 offset:20480
  ds_read_b64_tr_b16 v[54:55], v4 offset:20992
  s_waitcnt lgkmcnt(7)
  v_mfma_f32_16x16x32_bf16 v[8:11], v[40:43], v[96:99], v[8:11]
  ds_read_b128 v[104:107], v6 offset:12288
  ds_read_b64_tr_b16 v[24:25], v4 offset:24576
  ds_read_b64_tr_b16 v[26:27], v4 offset:25088
  s_waitcnt lgkmcnt(8)
  v_mfma_f32_16x16x32_bf16 v[12:15], v[44:47], v[96:99], v[12:15]
  ds_read_b64_tr_b16 v[28:29], v4 offset:28672
  ds_read_b64_tr_b16 v[30:31], v4 offset:29184
  s_waitcnt lgkmcnt(7)
  v_mfma_f32_16x16x32_bf16 v[8:11], v[48:51], v[100:103], v[8:11]
  ds_read_b128 v[108:111], v6 offset:13312
  ds_read_b64_tr_b16 v[32:33], v4 offset:32768
  ds_read_b64_tr_b16 v[34:35], v4 offset:33280
  s_waitcnt lgkmcnt(8)
  v_mfma_f32_16x16x32_bf16 v[12:15], v[52:55], v[100:103], v[12:15]
  ds_read_b64_tr_b16 v[36:37], v5 offset:0
  ds_read_b64_tr_b16 v[38:39], v5 offset:512
  s_waitcnt lgkmcnt(7)
  v_mfma_f32_16x16x32_bf16 v[8:11], v[24:27], v[104:107], v[8:11]
  ds_read_b128 v[112:115], v6 offset:14336
  ds_read_b64_tr_b16 v[40:41], v5 offset:4096
  ds_read_b64_tr_b16 v[42:43], v5 offset:4608
  s_waitcnt lgkmcnt(8)
  v_mfma_f32_16x16x32_bf16 v[12:15], v[28:31], v[104:107], v[12:15]
  ds_read_b64_tr_b16 v[44:45], v5 offset:8192
  ds_read_b64_tr_b16 v[46:47], v5 offset:8704
  s_waitcnt lgkmcnt(7)
  v_mfma_f32_16x16x32_bf16 v[8:11], v[32:35], v[108:111], v[8:11]
  ds_read_b128 v[116:119], v6 offset:15360
  ds_read_b64_tr_b16 v[48:49], v5 offset:12288
  ds_read_b64_tr_b16 v[50:51], v5 offset:12800
  s_waitcnt lgkmcnt(8)
  v_mfma_f32_16x16x32_bf16 v[12:15], v[36:39], v[108:111], v[12:15]
  ds_read_b64_tr_b16 v[52:53], v5 offset:16384
  ds_read_b64_tr_b16 v[54:55], v5 offset:16896
  s_waitcnt lgkmcnt(7)
  v_mfma_f32_16x16x32_bf16 v[8:11], v[40:43], v[112:115], v[8:11]
  ds_read_b64_tr_b16 v[24:25], v5 offset:20480
  ds_read_b64_tr_b16 v[26:27], v5 offset:20992
  s_waitcnt lgkmcnt(7)
  v_mfma_f32_16x16x32_bf16 v[12:15], v[44:47], v[112:115], v[12:15]
  ds_read_b64_tr_b16 v[28:29], v5 offset:24576
  ds_read_b64_tr_b16 v[30:31], v5 offset:25088
  s_waitcnt lgkmcnt(6)
  v_mfma_f32_16x16x32_bf16 v[8:11], v[48:51], v[116:119], v[8:11]
  ds_read_b64_tr_b16 v[32:33], v5 offset:28672
  ds_read_b64_tr_b16 v[34:35], v5 offset:29184
  s_waitcnt lgkmcnt(6)
  v_mfma_f32_16x16x32_bf16 v[12:15], v[52:55], v[116:119], v[12:15]
  ds_read_b64_tr_b16 v[36:37], v5 offset:32768
  ds_read_b64_tr_b16 v[38:39], v5 offset:33280
  s_waitcnt lgkmcnt(6)
  v_mfma_f32_16x16x32_bf16 v[8:11], v[24:27], v[120:123], v[8:11]
  s_waitcnt lgkmcnt(4)
  v_mfma_f32_16x16x32_bf16 v[12:15], v[28:31], v[120:123], v[12:15]
  s_waitcnt lgkmcnt(2)
  v_mfma_f32_16x16x32_bf16 v[8:11], v[32:35], v[124:127], v[8:11]
  s_waitcnt lgkmcnt(0)
  v_mfma_f32_16x16x32_bf16 v[12:15], v[36:39], v[124:127], v[12:15]
  s_nop 7
  v_add_f32_dpp v8, v12, v8 row_ror:8 row_mask:0xf bank_mask:0xf
  v_add_f32_dpp v9, v13, v9 row_ror:8 row_mask:0xf bank_mask:0xf
  v_add_f32_dpp v10, v14, v10 row_ror:8 row_mask:0xf bank_mask:0xf
  v_add_f32_dpp v11, v15, v11 row_ror:8 row_mask:0xf bank_mask:0xf
  v_min_u32 v8, -2, v8
  v_min_u32 v9, -2, v9
  v_min_u32 v10, -2, v10
  v_min_u32 v11, -2, v11
  s_mov_b32 exec_lo, 0x00ff00ff
  s_mov_b32 exec_hi, 0x00ff00ff
  buffer_store_dwordx4 v[8:11], v7, s[48:51], 0 offen sc1
  s_endpgm
L_R:
  s_mov_b32 s32, s4
  s_mov_b32 s33, s5
  s_mov_b32 s34, 9216
  s_mov_b32 s35, 0x20000
  s_mov_b32 s36, s22
  s_mov_b32 s37, s23
  s_mov_b32 s38, 9216
  s_mov_b32 s39, 0x20000
  v_and_b32 v1, 7, v0
  v_mul_u32_u24 v1, 1152, v1
  v_bfe_u32 v2, v0, 3, 2
  v_lshl_add_u32 v1, v2, 3, v1
  v_lshrrev_b32 v2, 5, v0
  v_lshl_add_u32 v1, v2, 2, v1
  s_lshl_b32 s30, s52, 5
  v_add_u32 v1, s30, v1
  buffer_load_dword v4, v1, s[32:35], 0 offen
  v_lshlrev_b32 v2, 4, v0
  s_lshl_b32 s30, s52, 11
  s_add_u32 s58, s30, 139264
  s_load_dword s64, s[24:25], 192
  s_waitcnt lgkmcnt(0)
  s_cmp_lg_u32 s64, 0
  s_cbranch_scc1 L_drd_r
  v_mov_b32 v12, 0
L_dr_r:
  global_load_dword v13, v12, s[24:25] offset:192 sc1
  s_waitcnt vmcnt(0)
  v_readfirstlane_b32 s64, v13
  s_cmp_lg_u32 s64, 0
  s_cbranch_scc1 L_drd_r
  s_sleep 16
  s_add_u32 s62, s62, 1
  s_cmp_lt_u32 s62, 0x40000
  s_cbranch_scc1 L_dr_r
L_drd_r:
  s_lshr_b32 s63, s64, 2
  s_and_b32 s64, s64, 1
  s_mul_hi_u32 s31, s52, 0x1c71c71d
  s_mul_i32 s30, s31, 9
  s_sub_u32 s30, s52, s30
  s_lshl_b32 s31, s31, 1
  s_cmp_ge_u32 s30, 5
  s_cselect_b32 s68, 5, 0
  s_cselect_b32 s69, 5, 4
  s_addc_u32 s31, s31, 0
  s_sub_u32 s30, s30, s68
  s_add_u32 s31, s31, s63
  s_and_b32 s31, s31, 7
  s_bitcmp1_b32 s31, 0
  s_cselect_b32 s69, s69, 0
  s_add_u32 s30, s30, s69
  s_bitcmp1_b32 s31, 1
  s_cselect_b32 s69, 9, 0
  s_add_u32 s30, s30, s69
  s_lshr_b32 s31, s31, 2
  s_lshr_b32 s68, s30, 1
  s_lshl_b32 s68, s68, 2
  s_and_b32 s69, s30, 1
  s_or_b32 s68, s68, s69
  s_xor_b32 s69, s31, s64
  s_lshl_b32 s69, s69, 1
  s_or_b32 s59, s68, s69
  s_lshl_b32 s59, s59, 12
  s_add_u32 s59, s59, 278528
  s_bfe_u32 s68, s58, 0x4000c
  s_lshl_b32 s68, s68, 23
  s_or_b32 s58, s58, s68
  s_bfe_u32 s68, s59, 0x4000c
  s_lshl_b32 s68, s68, 23
  s_or_b32 s59, s59, s68
  s_barrier
L_hg_y:
  buffer_load_dwordx4 v[40:43], v2, s[48:51], s58 offen sc1
  buffer_load_dwordx4 v[44:47], v2, s[48:51], s58 offen offset:1024 sc1
  s_waitcnt vmcnt(0)
  v_max3_u32 v32, v40, v41, v42
  v_max3_u32 v32, v32, v43, v44
  v_max3_u32 v32, v32, v45, v46
  v_max_u32 v32, v32, v47
  v_cmp_eq_u32 vcc, -1, v32
  s_cbranch_vccz L_hgd_y
  s_sleep 2
  s_add_u32 s62, s62, 1
  s_cmp_lt_u32 s62, 0x40000
  s_cbranch_scc1 L_hg_y
L_hgd_y:
  buffer_load_dwordx4 v[16:19], v2, s[48:51], s59 offen offset:0 sc1
  buffer_load_dwordx4 v[20:23], v2, s[48:51], s59 offen offset:1024 sc1
  buffer_load_dwordx4 v[24:27], v2, s[48:51], s59 offen offset:2048 sc1
  buffer_load_dwordx4 v[28:31], v2, s[48:51], s59 offen offset:3072 sc1
  v_pk_add_f32 v[40:41], v[40:41], v[44:45]
  v_pk_add_f32 v[42:43], v[42:43], v[46:47]
  s_nop 1
  v_permlane32_swap_b32 v40, v42
  v_permlane32_swap_b32 v41, v43
  v_pk_add_f32 v[40:41], v[40:41], v[42:43]
  v_cvt_pk_bf16_f32 v44, v40, v41
  v_lshlrev_b32 v40, 16, v44
  v_and_b32 v41, 0xffff0000, v44
  v_mul_f32 v44, 0xbfb8aa3b, v40
  v_mul_f32 v45, 0xbfb8aa3b, v41
  v_exp_f32 v44, v44
  v_exp_f32 v45, v45
  s_nop 0
  v_add_f32 v44, 1.0, v44
  v_add_f32 v45, 1.0, v45
  v_rcp_f32 v44, v44
  v_rcp_f32 v45, v45
  s_nop 0
  v_mul_f32 v8, v40, v44
  v_mul_f32 v9, v41, v45
  v_cvt_pk_bf16_f32 v44, v8, v9
  v_lshlrev_b32 v8, 16, v44
  v_and_b32 v9, 0xffff0000, v44
  v_lshlrev_b32 v12, 16, v4
  v_and_b32 v13, 0xffff0000, v4
  s_branch L_R_sw
L_R_s:
  buffer_load_dwordx4 v[16:19], v2, s[48:51], s59 offen offset:0 sc1
  buffer_load_dwordx4 v[20:23], v2, s[48:51], s59 offen offset:1024 sc1
  buffer_load_dwordx4 v[24:27], v2, s[48:51], s59 offen offset:2048 sc1
  buffer_load_dwordx4 v[28:31], v2, s[48:51], s59 offen offset:3072 sc1
L_R_sw:
  s_waitcnt vmcnt(0)
  v_max3_u32 v32, v16, v17, v18
  v_max3_u32 v32, v32, v19, v20
  v_max3_u32 v32, v32, v21, v22
  v_max3_u32 v32, v32, v23, v24
  v_max3_u32 v32, v32, v25, v26
  v_max3_u32 v32, v32, v27, v28
  v_max3_u32 v32, v32, v29, v30
  v_max_u32 v32, v32, v31
  v_cmp_eq_u32 vcc, -1, v32
  s_cbranch_vccz L_Rd_s
  s_add_u32 s62, s62, 1
  s_cmp_lt_u32 s62, 0x40000
  s_cbranch_scc1 L_R_s
L_Rd_s:
  v_pk_add_f32 v[16:17], v[16:17], v[20:21]
  v_pk_add_f32 v[18:19], v[18:19], v[22:23]
  v_pk_add_f32 v[24:25], v[24:25], v[28:29]
  v_pk_add_f32 v[26:27], v[26:27], v[30:31]
  v_pk_add_f32 v[16:17], v[16:17], v[24:25]
  v_pk_add_f32 v[18:19], v[18:19], v[26:27]
  s_nop 1
  v_permlane32_swap_b32 v16, v18
  v_permlane32_swap_b32 v17, v19
  v_pk_add_f32 v[16:17], v[16:17], v[18:19]
  v_cvt_pk_bf16_f32 v20, v16, v17
  v_lshlrev_b32 v16, 16, v20
  v_and_b32 v17, 0xffff0000, v20
  v_pk_mul_f32 v[16:17], v[16:17], v[8:9]
  v_cvt_pk_bf16_f32 v20, v16, v17
  v_lshlrev_b32 v16, 16, v20
  v_and_b32 v17, 0xffff0000, v20
  v_pk_add_f32 v[16:17], v[16:17], v[12:13]
  v_cvt_pk_bf16_f32 v20, v16, v17
  buffer_store_dword v20, v1, s[36:39], 0 offen sc1
L_end:
  s_endpgm
.section .rodata,"a"
.p2align 6
.amdhsa_kernel recurrent_scan__sliding_block_cached__glu_gated_bilinear__decode_kernel
.amdhsa_next_free_vgpr 128
.amdhsa_next_free_sgpr 100
.amdhsa_accum_offset 128
.amdhsa_group_segment_fixed_size 0
.amdhsa_kernarg_size 96
.amdhsa_user_sgpr_count 2
.amdhsa_user_sgpr_kernarg_segment_ptr 1
.amdhsa_system_sgpr_workgroup_id_x 1
.amdhsa_float_denorm_mode_32 3
.end_amdhsa_kernel
```
